```python
import torch

def _softmax(x, axis=-1):
    return torch.softmax(x, dim=axis)
def _gelu(x):
    return torch.nn.functional.gelu(x, approximate="tanh")
def _silu(x):
    return torch.nn.functional.silu(x)
def _sigmoid(x):
    return torch.sigmoid(x)
def _layernorm(x, axis=-1, eps=1e-5):
    m = x.mean(dim=axis, keepdim=True)
    v = x.var(dim=axis, keepdim=True, unbiased=False)
    return (x - m) / torch.sqrt(v + eps)
def _scatter_add(tgt, idx, src, axis=0):
    return tgt.clone().index_add_(axis, idx, src)
def _segment_sum(src, seg, n):
    out = torch.zeros((n,) + src.shape[1:], dtype=src.dtype)
    return out.index_add_(0, seg, src)
def _pad(x, pw):
    flat = tuple(v for pair in reversed(pw) for v in pair)
    return torch.nn.functional.pad(x, flat)

kernel_name = 'concat_heads__sliding_block_cached__sliding_block_cached__decode'

def setup_inputs():

    _w = (lambda a: (lambda t: t.to(torch.bfloat16) if t.is_floating_point() else t)(torch.as_tensor(a)))
    def _A_setup():
        B, Sq, D = 2, 1, 576
        Hq, Hkv, Sk, Dh = 32, 16, 16384, 128
        assert Hq % Hkv == 0, (Hq, Hkv)
        return {
            "x": _w((lambda *s: torch.randn(*s, dtype=torch.bfloat16) * 0.8)(B, Sq, D)),
            "k_cache": _w((lambda *s: torch.randn(*s, dtype=torch.bfloat16) * 0.8)(B, Hkv, Sk, Dh)),
            "v_cache": _w((lambda *s: torch.randn(*s, dtype=torch.bfloat16) * 0.05)(B, Hkv, Sk, Dh)),
            "wq": _w((lambda *s: torch.randn(*s, dtype=torch.bfloat16) * 0.8)(D, Hq * Dh) * (D ** -0.5)),
            "wo": _w((lambda *s: torch.randn(*s, dtype=torch.bfloat16) * 0.05)(Hq * Dh, D) * ((Hq * Dh) ** -0.5)),
        }
    _A_in = _A_setup()

    def _B_setup():
        B, Sq, D = 2, 1, 576
        Hq, Hkv, Sk, Dh = 32, 16, 16384, 128
        assert Hq % Hkv == 0, (Hq, Hkv)
        return {
            "x": _w((lambda *s: torch.randn(*s, dtype=torch.bfloat16) * 0.8)(B, Sq, D)),
            "k_cache": _w((lambda *s: torch.randn(*s, dtype=torch.bfloat16) * 0.8)(B, Hkv, Sk, Dh)),
            "v_cache": _w((lambda *s: torch.randn(*s, dtype=torch.bfloat16) * 0.05)(B, Hkv, Sk, Dh)),
            "wq": _w((lambda *s: torch.randn(*s, dtype=torch.bfloat16) * 0.8)(D, Hq * Dh) * (D ** -0.5)),
            "wo": _w((lambda *s: torch.randn(*s, dtype=torch.bfloat16) * 0.05)(Hq * Dh, D) * ((Hq * Dh) ** -0.5)),
        }
    _B_in = _B_setup()

    return {
        "A_x": _A_in["x"],
        "A_k_cache": _A_in["k_cache"],
        "A_v_cache": _A_in["v_cache"],
        "A_wq": _A_in["wq"],
        "A_wo": _A_in["wo"],
        "B_x": _B_in["x"],
        "B_k_cache": _B_in["k_cache"],
        "B_v_cache": _B_in["v_cache"],
        "B_wq": _B_in["wq"],
        "B_wo": _B_in["wo"],
    }

def reference(A_x, A_k_cache, A_v_cache, A_wq, A_wo, B_x, B_k_cache, B_v_cache, B_wq, B_wo):
    def _A_ref(x, k_cache, v_cache, wq, wo):
        B, Sq, D = x.shape
        Hq, Dh = 32, 128
        Hkv, Sk = k_cache.shape[1], k_cache.shape[2]
        W = min(4096, max(256, Sk // 4))
        rep = Hq // Hkv
        q = (lambda x, *d: x.permute(*d))((x @ wq).reshape(B, Sq, Hq, Dh), 0, 2, 1, 3)
        k = (lambda x, n, axis: torch.repeat_interleave(x, n, dim=axis))(k_cache[:, :, Sk - W:, :], rep, axis=1)
        v = (lambda x, n, axis: torch.repeat_interleave(x, n, dim=axis))(v_cache[:, :, Sk - W:, :], rep, axis=1)
        scores = torch.einsum("bhqd,bhkd->bhqk", q, k) * (Dh ** -0.5)
        p = _softmax(scores, axis=-1)
        o = torch.einsum("bhqk,bhkd->bhqd", p, v)
        return (lambda x, *d: x.permute(*d))(o, 0, 2, 1, 3).reshape(B, Sq, Hq * Dh) @ wo

    def _B_ref(x, k_cache, v_cache, wq, wo):
        B, Sq, D = x.shape
        Hq, Dh = 32, 128
        Hkv, Sk = k_cache.shape[1], k_cache.shape[2]
        W = min(4096, max(256, Sk // 4))
        rep = Hq // Hkv
        q = (lambda x, *d: x.permute(*d))((x @ wq).reshape(B, Sq, Hq, Dh), 0, 2, 1, 3)
        k = (lambda x, n, axis: torch.repeat_interleave(x, n, dim=axis))(k_cache[:, :, Sk - W:, :], rep, axis=1)
        v = (lambda x, n, axis: torch.repeat_interleave(x, n, dim=axis))(v_cache[:, :, Sk - W:, :], rep, axis=1)
        scores = torch.einsum("bhqd,bhkd->bhqk", q, k) * (Dh ** -0.5)
        p = _softmax(scores, axis=-1)
        o = torch.einsum("bhqk,bhkd->bhqd", p, v)
        return (lambda x, *d: x.permute(*d))(o, 0, 2, 1, 3).reshape(B, Sq, Hq * Dh) @ wo

    a = _A_ref(A_x, A_k_cache, A_v_cache, A_wq, A_wo)
    b = _B_ref(B_x, B_k_cache, B_v_cache, B_wq, B_wo)
    return torch.concatenate([a, b], axis=-1)
```

```asm
; @launch grid=(256,1,1) block=(512,1,1) lds=9472
.amdgcn_target "amdgcn-amd-amdhsa--gfx950"
.text
.globl concat_heads__sliding_block_cached__sliding_block_cached__decode_kernel
.p2align 8
.type concat_heads__sliding_block_cached__sliding_block_cached__decode_kernel,@function
concat_heads__sliding_block_cached__sliding_block_cached__decode_kernel:
    s_cmp_ge_u32 s2, 256
    s_cbranch_scc1 L_end
    s_load_dwordx16 s[8:23], s[0:1], 0
    s_load_dwordx4 s[24:27], s[0:1], 64
    s_load_dwordx4 s[28:31], s[0:1], 88
    s_load_dwordx2 s[84:85], s[0:1], 80
    s_movk_i32 s86, 4608
    s_mov_b32 s87, 0x00020000
    v_lshrrev_b32 v22, 6, v0
    v_and_b32 v23, 63, v0
    v_readfirstlane_b32 s60, v22
    s_and_b32 s3, s2, 7
    s_lshr_b32 s4, s2, 3
    s_lshl_b32 s3, s3, 2
    s_and_b32 s5, s4, 3
    s_or_b32 s61, s3, s5
    s_lshr_b32 s68, s4, 2
    s_lshr_b32 s5, s61, 4
    s_and_b32 s3, s61, 15
    s_lshr_b32 s69, s68, 2
    s_and_b32 s7, s68, 3
    v_lshrrev_b32 v24, 4, v23
    v_and_b32 v25, 15, v23
    v_and_b32 v26, 3, v25
    v_lshlrev_b32 v26, 4, v26
    v_lshrrev_b32 v27, 2, v25
    v_lshlrev_b32 v27, 8, v27
    v_lshlrev_b32 v28, 6, v24
    v_add3_u32 v1, v26, v27, v28
    v_lshlrev_b32 v2, 4, v23
    s_lshl_b32 s32, s69, 4
    s_or_b32 s32, s32, s3
    s_lshl_b32 s32, s32, 22
    s_add_u32 s32, s32, 0x300000
    s_lshl_b32 s62, s60, 12
    s_lshl_b32 s33, s7, 15
    s_add_u32 s62, s62, s33
    s_lshl_b32 s33, s61, 1
    s_add_u32 s33, s33, s69
    s_and_b32 s33, s33, 7
    s_lshl_b32 s33, s33, 17
    s_add_u32 s62, s62, s33
    s_mov_b32 s63, s62
    s_lshr_b32 s34, s68, 1
    s_mul_i32 s35, s34, 288
    s_mul_i32 s34, s34, 1179648
    s_lshl_b32 s33, s3, 9
    s_add_u32 s34, s34, s33
    s_and_b32 s33, s68, 1
    s_lshl_b32 s33, s33, 8
    s_add_u32 s34, s34, s33
    s_lshl_b32 s33, s3, 3
    s_add_u32 s33, s33, s68
    s_lshl_b32 s6, s5, 8
    s_add_u32 s88, s6, s33
    s_mul_i32 s88, s88, 2304
    s_mul_i32 s33, s33, 36864
    v_mov_b32 v14, 0
    ds_write_b32 v14, v14 offset:512
    s_lshl_b32 s91, s5, 8
    s_add_u32 s91, s91, 0x230000
    s_cmp_eq_u32 s5, 0
    s_waitcnt lgkmcnt(0)
    s_load_dword s90, s[30:31], s91
    s_cselect_b64 s[36:37], s[10:11], s[20:21]
    s_cselect_b64 s[40:41], s[12:13], s[22:23]
    s_cselect_b64 s[52:53], s[8:9], s[18:19]
    s_cselect_b64 s[44:45], s[14:15], s[24:25]
    s_cselect_b64 s[48:49], s[16:17], s[26:27]
    s_add_u32 s36, s36, s32
    s_addc_u32 s37, s37, 0
    s_mov_b32 s38, 0x100000
    s_mov_b32 s39, 0x00020000
    s_add_u32 s40, s40, s32
    s_addc_u32 s41, s41, 0
    s_mov_b32 s42, 0x100000
    s_mov_b32 s43, 0x00020000
    s_add_u32 s52, s52, s35
    s_addc_u32 s53, s53, 0
    s_mov_b32 s54, 1440
    s_mov_b32 s55, 0x00020000
    s_add_u32 s44, s44, s34
    s_addc_u32 s45, s45, 0
    s_mov_b32 s46, 1171712
    s_mov_b32 s47, 0x00020000
    s_add_u32 s48, s48, s33
    s_addc_u32 s49, s49, 0
    s_mov_b32 s50, 36864
    s_mov_b32 s51, 0x00020000
    s_mov_b32 s56, s30
    s_mov_b32 s57, s31
    s_mov_b32 s58, 0x240000
    s_mov_b32 s59, 0x00020000
    s_cmp_lg_u32 s60, 0
    s_cbranch_scc1 L_strm
    v_lshrrev_b32 v26, 3, v25
    v_mul_u32_u24 v26, 1152, v26
    v_mul_u32_u24 v27, 72, v24
    v_add_u32 v5, v26, v27
    v_mul_u32_u24 v26, 294912, v24
    v_lshl_add_u32 v3, v25, 4, v26
    buffer_load_dwordx4 v[46:49], v5, s[52:55], 0 offen offset:0
    buffer_load_dwordx4 v[50:53], v5, s[52:55], 0 offen offset:16
    buffer_load_dwordx4 v[54:57], v5, s[52:55], 0 offen offset:32
    buffer_load_dwordx4 v[58:61], v5, s[52:55], 0 offen offset:48
    buffer_load_dwordx2 v[62:63], v5, s[52:55], 0 offen offset:64
    s_mov_b32 s64, 0
    buffer_load_dwordx4 v[112:115], v3, s[44:47], s64 offen nt
    s_add_u32 s64, s64, 0x2000
    buffer_load_dwordx4 v[116:119], v3, s[44:47], s64 offen nt
    s_add_u32 s64, s64, 0x2000
    buffer_load_dwordx4 v[120:123], v3, s[44:47], s64 offen nt
    s_add_u32 s64, s64, 0x2000
    buffer_load_dwordx4 v[124:127], v3, s[44:47], s64 offen nt
    s_add_u32 s64, s64, 0x2000
    buffer_load_dwordx4 v[128:131], v3, s[44:47], s64 offen nt
    s_add_u32 s64, s64, 0x2000
    buffer_load_dwordx4 v[132:135], v3, s[44:47], s64 offen nt
    s_add_u32 s64, s64, 0x2000
    buffer_load_dwordx4 v[136:139], v3, s[44:47], s64 offen nt
    s_add_u32 s64, s64, 0x2000
    buffer_load_dwordx4 v[140:143], v3, s[44:47], s64 offen nt
    s_add_u32 s64, s64, 0x2000
    buffer_load_dwordx4 v[144:147], v3, s[44:47], s64 offen nt
    s_add_u32 s64, s64, 0x2000
    buffer_load_dwordx4 v[148:151], v3, s[44:47], s64 offen nt
    s_add_u32 s64, s64, 0x2000
    buffer_load_dwordx4 v[152:155], v3, s[44:47], s64 offen nt
    s_add_u32 s64, s64, 0x2000
    buffer_load_dwordx4 v[156:159], v3, s[44:47], s64 offen nt
    s_add_u32 s64, s64, 0x2000
    buffer_load_dwordx4 v[160:163], v3, s[44:47], s64 offen nt
    s_add_u32 s64, s64, 0x2000
    buffer_load_dwordx4 v[164:167], v3, s[44:47], s64 offen nt
    s_add_u32 s64, s64, 0x2000
    buffer_load_dwordx4 v[168:171], v3, s[44:47], s64 offen nt
    s_add_u32 s64, s64, 0x2000
    buffer_load_dwordx4 v[172:175], v3, s[44:47], s64 offen nt
    s_add_u32 s64, s64, 0x2000
    buffer_load_dwordx4 v[176:179], v3, s[44:47], s64 offen nt
    s_add_u32 s64, s64, 0x2000
    buffer_load_dwordx4 v[180:183], v3, s[44:47], s64 offen nt
    s_add_u32 s64, s64, 0x2000
    buffer_load_dwordx4 v[184:187], v3, s[44:47], s64 offen nt
    s_add_u32 s64, s64, 0x2000
    buffer_load_dwordx4 v[188:191], v3, s[44:47], s64 offen nt
    s_add_u32 s64, s64, 0x2000
    buffer_load_dwordx4 v[192:195], v3, s[44:47], s64 offen nt
    s_add_u32 s64, s64, 0x2000
    buffer_load_dwordx4 v[196:199], v3, s[44:47], s64 offen nt
    s_add_u32 s64, s64, 0x2000
    buffer_load_dwordx4 v[200:203], v3, s[44:47], s64 offen nt
    s_add_u32 s64, s64, 0x2000
    buffer_load_dwordx4 v[204:207], v3, s[44:47], s64 offen nt
    s_add_u32 s64, s64, 0x2000
    buffer_load_dwordx4 v[208:211], v3, s[44:47], s64 offen nt
    s_add_u32 s64, s64, 0x2000
    buffer_load_dwordx4 v[212:215], v3, s[44:47], s64 offen nt
    s_add_u32 s64, s64, 0x2000
    buffer_load_dwordx4 v[216:219], v3, s[44:47], s64 offen nt
    s_add_u32 s64, s64, 0x2000
    buffer_load_dwordx4 v[220:223], v3, s[44:47], s64 offen nt
    s_add_u32 s64, s64, 0x2000
    buffer_load_dwordx4 v[224:227], v3, s[44:47], s64 offen nt
    s_add_u32 s64, s64, 0x2000
    buffer_load_dwordx4 v[228:231], v3, s[44:47], s64 offen nt
    s_add_u32 s64, s64, 0x2000
    buffer_load_dwordx4 v[232:235], v3, s[44:47], s64 offen nt
    s_add_u32 s64, s64, 0x2000
    buffer_load_dwordx4 v[236:239], v3, s[44:47], s64 offen nt
    s_add_u32 s64, s64, 0x2000
    buffer_load_dwordx4 v[240:243], v3, s[44:47], s64 offen nt
    s_add_u32 s64, s64, 0x2000
    buffer_load_dwordx4 v[244:247], v3, s[44:47], s64 offen nt
    s_add_u32 s64, s64, 0x2000
    buffer_load_dwordx4 v[248:251], v3, s[44:47], s64 offen nt
    s_add_u32 s64, s64, 0x2000
    buffer_load_dwordx4 v[252:255], v3, s[44:47], s64 offen nt
    s_add_u32 s64, s64, 0x2000
    s_barrier
    s_mov_b32 s66, 0x3db504f3
    s_mov_b32 s67, 0x3fb8aa3b
    s_movk_i32 s65, 4608
    v_lshrrev_b32 v26, 3, v23
    v_and_b32 v27, 7, v23
    v_and_b32 v28, 1, v27
    v_lshlrev_b32 v28, 4, v28
    v_mov_b32 v29, 0xffff
    v_lshlrev_b32 v28, v28, v29
    v_lshrrev_b32 v29, 1, v27
    v_cmp_eq_u32 vcc, 0, v29
    s_nop 1
    v_cndmask_b32 v6, 0, v28, vcc
    v_cmp_eq_u32 vcc, 1, v29
    s_nop 1
    v_cndmask_b32 v7, 0, v28, vcc
    v_cmp_eq_u32 vcc, 2, v29
    s_nop 1
    v_cndmask_b32 v8, 0, v28, vcc
    v_cmp_eq_u32 vcc, 3, v29
    s_nop 1
    v_cndmask_b32 v9, 0, v28, vcc
    v_and_b32 v26, 1, v26
    v_lshrrev_b32 v28, 1, v24
    v_lshlrev_b32 v28, 9, v28
    v_lshl_add_u32 v28, v25, 5, v28
    v_and_b32 v29, 1, v24
    v_lshl_add_u32 v28, v29, 4, v28
    v_mul_u32_u24 v4, 9216, v24
    v_subrev_u32 v29, 3, v22
    v_lshlrev_b32 v29, 4, v29
    v_add_u32 v29, v29, v25
    v_lshl_add_u32 v4, v29, 4, v4
    v_cmp_gt_u32 vcc, 72, v29
    v_mov_b32 v27, 0x7ff00000
    s_nop 0
    v_cndmask_b32 v4, v27, v4, vcc
    v_lshrrev_b32 v5, 1, v24
    v_mul_u32_u24 v5, 294912, v5
    v_lshl_add_u32 v5, v25, 4, v5
    s_sub_u32 s32, s60, 3
    s_lshl_b32 s32, s32, 9
    s_cmp_eq_u32 s60, 7
    s_cselect_b32 s33, 7, 8
    v_and_b32 v29, 1, v24
    v_lshlrev_b32 v29, s33, v29
    v_add3_u32 v5, v29, s32, v5
    v_cndmask_b32 v27, v27, v5, vcc
    s_mov_b32 s32, 0x01000100
    s_mov_b32 s33, 0x03020302
    s_waitcnt vmcnt(36)
    v_perm_b32 v5, v46, v46, s32
    v_and_b32 v14, v5, v6
    v_and_b32 v15, v5, v7
    v_and_b32 v16, v5, v8
    v_and_b32 v17, v5, v9
    s_waitcnt vmcnt(35)
    s_nop 0
    v_mfma_f32_16x16x32_bf16 v[10:13], v[14:17], v[112:115], 0
    v_perm_b32 v5, v46, v46, s33
    v_and_b32 v18, v5, v6
    v_and_b32 v19, v5, v7
    v_and_b32 v20, v5, v8
    v_and_b32 v21, v5, v9
    s_waitcnt vmcnt(34)
    s_nop 0
    v_mfma_f32_16x16x32_bf16 v[10:13], v[18:21], v[116:119], v[10:13]
    v_perm_b32 v5, v47, v47, s32
    v_and_b32 v14, v5, v6
    v_and_b32 v15, v5, v7
    v_and_b32 v16, v5, v8
    v_and_b32 v17, v5, v9
    s_waitcnt vmcnt(33)
    s_nop 0
    v_mfma_f32_16x16x32_bf16 v[10:13], v[14:17], v[120:123], v[10:13]
    v_perm_b32 v5, v47, v47, s33
    v_and_b32 v18, v5, v6
    v_and_b32 v19, v5, v7
    v_and_b32 v20, v5, v8
    v_and_b32 v21, v5, v9
    s_waitcnt vmcnt(32)
    s_nop 0
    v_mfma_f32_16x16x32_bf16 v[10:13], v[18:21], v[124:127], v[10:13]
    v_perm_b32 v5, v48, v48, s32
    v_and_b32 v14, v5, v6
    v_and_b32 v15, v5, v7
    v_and_b32 v16, v5, v8
    v_and_b32 v17, v5, v9
    s_waitcnt vmcnt(31)
    s_nop 0
    v_mfma_f32_16x16x32_bf16 v[10:13], v[14:17], v[128:131], v[10:13]
    v_perm_b32 v5, v48, v48, s33
    v_and_b32 v18, v5, v6
    v_and_b32 v19, v5, v7
    v_and_b32 v20, v5, v8
    v_and_b32 v21, v5, v9
    s_waitcnt vmcnt(30)
    s_nop 0
    v_mfma_f32_16x16x32_bf16 v[10:13], v[18:21], v[132:135], v[10:13]
    v_perm_b32 v5, v49, v49, s32
    v_and_b32 v14, v5, v6
    v_and_b32 v15, v5, v7
    v_and_b32 v16, v5, v8
    v_and_b32 v17, v5, v9
    s_waitcnt vmcnt(29)
    s_nop 0
    v_mfma_f32_16x16x32_bf16 v[10:13], v[14:17], v[136:139], v[10:13]
    v_perm_b32 v5, v49, v49, s33
    v_and_b32 v18, v5, v6
    v_and_b32 v19, v5, v7
    v_and_b32 v20, v5, v8
    v_and_b32 v21, v5, v9
    s_waitcnt vmcnt(28)
    s_nop 0
    v_mfma_f32_16x16x32_bf16 v[10:13], v[18:21], v[140:143], v[10:13]
    v_perm_b32 v5, v50, v50, s32
    v_and_b32 v14, v5, v6
    v_and_b32 v15, v5, v7
    v_and_b32 v16, v5, v8
    v_and_b32 v17, v5, v9
    s_waitcnt vmcnt(27)
    s_nop 0
    v_mfma_f32_16x16x32_bf16 v[10:13], v[14:17], v[144:147], v[10:13]
    v_perm_b32 v5, v50, v50, s33
    v_and_b32 v18, v5, v6
    v_and_b32 v19, v5, v7
    v_and_b32 v20, v5, v8
    v_and_b32 v21, v5, v9
    s_waitcnt vmcnt(26)
    s_nop 0
    v_mfma_f32_16x16x32_bf16 v[10:13], v[18:21], v[148:151], v[10:13]
    v_perm_b32 v5, v51, v51, s32
    v_and_b32 v14, v5, v6
    v_and_b32 v15, v5, v7
    v_and_b32 v16, v5, v8
    v_and_b32 v17, v5, v9
    s_waitcnt vmcnt(25)
    s_nop 0
    v_mfma_f32_16x16x32_bf16 v[10:13], v[14:17], v[152:155], v[10:13]
    v_perm_b32 v5, v51, v51, s33
    v_and_b32 v18, v5, v6
    v_and_b32 v19, v5, v7
    v_and_b32 v20, v5, v8
    v_and_b32 v21, v5, v9
    s_waitcnt vmcnt(24)
    s_nop 0
    v_mfma_f32_16x16x32_bf16 v[10:13], v[18:21], v[156:159], v[10:13]
    v_perm_b32 v5, v52, v52, s32
    v_and_b32 v14, v5, v6
    v_and_b32 v15, v5, v7
    v_and_b32 v16, v5, v8
    v_and_b32 v17, v5, v9
    s_waitcnt vmcnt(23)
    s_nop 0
    v_mfma_f32_16x16x32_bf16 v[10:13], v[14:17], v[160:163], v[10:13]
    v_perm_b32 v5, v52, v52, s33
    v_and_b32 v18, v5, v6
    v_and_b32 v19, v5, v7
    v_and_b32 v20, v5, v8
    v_and_b32 v21, v5, v9
    s_waitcnt vmcnt(22)
    s_nop 0
    v_mfma_f32_16x16x32_bf16 v[10:13], v[18:21], v[164:167], v[10:13]
    v_perm_b32 v5, v53, v53, s32
    v_and_b32 v14, v5, v6
    v_and_b32 v15, v5, v7
    v_and_b32 v16, v5, v8
    v_and_b32 v17, v5, v9
    s_waitcnt vmcnt(21)
    s_nop 0
    v_mfma_f32_16x16x32_bf16 v[10:13], v[14:17], v[168:171], v[10:13]
    v_perm_b32 v5, v53, v53, s33
    v_and_b32 v18, v5, v6
    v_and_b32 v19, v5, v7
    v_and_b32 v20, v5, v8
    v_and_b32 v21, v5, v9
    s_waitcnt vmcnt(20)
    s_nop 0
    v_mfma_f32_16x16x32_bf16 v[10:13], v[18:21], v[172:175], v[10:13]
    v_perm_b32 v5, v54, v54, s32
    v_and_b32 v14, v5, v6
    v_and_b32 v15, v5, v7
    v_and_b32 v16, v5, v8
    v_and_b32 v17, v5, v9
    s_waitcnt vmcnt(19)
    s_nop 0
    v_mfma_f32_16x16x32_bf16 v[10:13], v[14:17], v[176:179], v[10:13]
    v_perm_b32 v5, v54, v54, s33
    v_and_b32 v18, v5, v6
    v_and_b32 v19, v5, v7
    v_and_b32 v20, v5, v8
    v_and_b32 v21, v5, v9
    s_waitcnt vmcnt(18)
    s_nop 0
    v_mfma_f32_16x16x32_bf16 v[10:13], v[18:21], v[180:183], v[10:13]
    v_perm_b32 v5, v55, v55, s32
    v_and_b32 v14, v5, v6
    v_and_b32 v15, v5, v7
    v_and_b32 v16, v5, v8
    v_and_b32 v17, v5, v9
    s_waitcnt vmcnt(17)
    s_nop 0
    v_mfma_f32_16x16x32_bf16 v[10:13], v[14:17], v[184:187], v[10:13]
    v_perm_b32 v5, v55, v55, s33
    v_and_b32 v18, v5, v6
    v_and_b32 v19, v5, v7
    v_and_b32 v20, v5, v8
    v_and_b32 v21, v5, v9
    s_waitcnt vmcnt(16)
    s_nop 0
    v_mfma_f32_16x16x32_bf16 v[10:13], v[18:21], v[188:191], v[10:13]
    v_perm_b32 v5, v56, v56, s32
    v_and_b32 v14, v5, v6
    v_and_b32 v15, v5, v7
    v_and_b32 v16, v5, v8
    v_and_b32 v17, v5, v9
    s_waitcnt vmcnt(15)
    s_nop 0
    v_mfma_f32_16x16x32_bf16 v[10:13], v[14:17], v[192:195], v[10:13]
    v_perm_b32 v5, v56, v56, s33
    v_and_b32 v18, v5, v6
    v_and_b32 v19, v5, v7
    v_and_b32 v20, v5, v8
    v_and_b32 v21, v5, v9
    s_waitcnt vmcnt(14)
    s_nop 0
    v_mfma_f32_16x16x32_bf16 v[10:13], v[18:21], v[196:199], v[10:13]
    v_perm_b32 v5, v57, v57, s32
    v_and_b32 v14, v5, v6
    v_and_b32 v15, v5, v7
    v_and_b32 v16, v5, v8
    v_and_b32 v17, v5, v9
    s_waitcnt vmcnt(13)
    s_nop 0
    v_mfma_f32_16x16x32_bf16 v[10:13], v[14:17], v[200:203], v[10:13]
    v_perm_b32 v5, v57, v57, s33
    v_and_b32 v18, v5, v6
    v_and_b32 v19, v5, v7
    v_and_b32 v20, v5, v8
    v_and_b32 v21, v5, v9
    s_waitcnt vmcnt(12)
    s_nop 0
    v_mfma_f32_16x16x32_bf16 v[10:13], v[18:21], v[204:207], v[10:13]
    v_perm_b32 v5, v58, v58, s32
    v_and_b32 v14, v5, v6
    v_and_b32 v15, v5, v7
    v_and_b32 v16, v5, v8
    v_and_b32 v17, v5, v9
    s_waitcnt vmcnt(11)
    s_nop 0
    v_mfma_f32_16x16x32_bf16 v[10:13], v[14:17], v[208:211], v[10:13]
    v_perm_b32 v5, v58, v58, s33
    v_and_b32 v18, v5, v6
    v_and_b32 v19, v5, v7
    v_and_b32 v20, v5, v8
    v_and_b32 v21, v5, v9
    s_waitcnt vmcnt(10)
    s_nop 0
    v_mfma_f32_16x16x32_bf16 v[10:13], v[18:21], v[212:215], v[10:13]
    v_perm_b32 v5, v59, v59, s32
    v_and_b32 v14, v5, v6
    v_and_b32 v15, v5, v7
    v_and_b32 v16, v5, v8
    v_and_b32 v17, v5, v9
    s_waitcnt vmcnt(9)
    s_nop 0
    v_mfma_f32_16x16x32_bf16 v[10:13], v[14:17], v[216:219], v[10:13]
    v_perm_b32 v5, v59, v59, s33
    v_and_b32 v18, v5, v6
    v_and_b32 v19, v5, v7
    v_and_b32 v20, v5, v8
    v_and_b32 v21, v5, v9
    s_waitcnt vmcnt(8)
    s_nop 0
    v_mfma_f32_16x16x32_bf16 v[10:13], v[18:21], v[220:223], v[10:13]
    v_perm_b32 v5, v60, v60, s32
    v_and_b32 v14, v5, v6
    v_and_b32 v15, v5, v7
    v_and_b32 v16, v5, v8
    v_and_b32 v17, v5, v9
    s_waitcnt vmcnt(7)
    s_nop 0
    v_mfma_f32_16x16x32_bf16 v[10:13], v[14:17], v[224:227], v[10:13]
    v_perm_b32 v5, v60, v60, s33
    v_and_b32 v18, v5, v6
    v_and_b32 v19, v5, v7
    v_and_b32 v20, v5, v8
    v_and_b32 v21, v5, v9
    s_waitcnt vmcnt(6)
    s_nop 0
    v_mfma_f32_16x16x32_bf16 v[10:13], v[18:21], v[228:231], v[10:13]
    v_perm_b32 v5, v61, v61, s32
    v_and_b32 v14, v5, v6
    v_and_b32 v15, v5, v7
    v_and_b32 v16, v5, v8
    v_and_b32 v17, v5, v9
    s_waitcnt vmcnt(5)
    s_nop 0
    v_mfma_f32_16x16x32_bf16 v[10:13], v[14:17], v[232:235], v[10:13]
    v_perm_b32 v5, v61, v61, s33
    v_and_b32 v18, v5, v6
    v_and_b32 v19, v5, v7
    v_and_b32 v20, v5, v8
    v_and_b32 v21, v5, v9
    s_waitcnt vmcnt(4)
    s_nop 0
    v_mfma_f32_16x16x32_bf16 v[10:13], v[18:21], v[236:239], v[10:13]
    v_perm_b32 v5, v62, v62, s32
    v_and_b32 v14, v5, v6
    v_and_b32 v15, v5, v7
    v_and_b32 v16, v5, v8
    v_and_b32 v17, v5, v9
    s_waitcnt vmcnt(3)
    s_nop 0
    v_mfma_f32_16x16x32_bf16 v[10:13], v[14:17], v[240:243], v[10:13]
    v_perm_b32 v5, v62, v62, s33
    v_and_b32 v18, v5, v6
    v_and_b32 v19, v5, v7
    v_and_b32 v20, v5, v8
    v_and_b32 v21, v5, v9
    s_waitcnt vmcnt(2)
    s_nop 0
    v_mfma_f32_16x16x32_bf16 v[10:13], v[18:21], v[244:247], v[10:13]
    v_perm_b32 v5, v63, v63, s32
    v_and_b32 v14, v5, v6
    v_and_b32 v15, v5, v7
    v_and_b32 v16, v5, v8
    v_and_b32 v17, v5, v9
    s_waitcnt vmcnt(1)
    s_nop 0
    v_mfma_f32_16x16x32_bf16 v[10:13], v[14:17], v[248:251], v[10:13]
    v_perm_b32 v5, v63, v63, s33
    v_and_b32 v18, v5, v6
    v_and_b32 v19, v5, v7
    v_and_b32 v20, v5, v8
    v_and_b32 v21, v5, v9
    s_waitcnt vmcnt(0)
    s_nop 0
    v_mfma_f32_16x16x32_bf16 v[10:13], v[18:21], v[252:255], v[10:13]
    s_waitcnt lgkmcnt(0)
    s_add_u32 s90, s90, 1
    s_max_u32 s90, s90, 1
    s_lshl_b32 s34, s61, 3
    s_add_u32 s35, s34, s68
    s_lshl_b32 s35, s35, 10
    s_add_u32 s35, s35, 0x120000
    s_nop 4
    v_mov_b32 v14, s90
    s_mov_b32 s32, 0x07060500
    v_perm_b32 v10, v10, v14, s32
    s_mov_b32 s32, 0x07060501
    v_perm_b32 v11, v11, v14, s32
    s_mov_b32 s32, 0x07060502
    v_perm_b32 v12, v12, v14, s32
    s_mov_b32 s32, 0x07060503
    v_perm_b32 v13, v13, v14, s32
    buffer_store_dwordx4 v[10:13], v28, s[56:59], s35 offen sc1
    buffer_load_dwordx4 v[80:83], v1, s[36:39], s62 offen offset:0 nt
    buffer_load_dwordx4 v[84:87], v1, s[36:39], s62 offen offset:1024 nt
    buffer_load_dwordx4 v[88:91], v1, s[36:39], s62 offen offset:2048 nt
    s_waitcnt vmcnt(3)
    buffer_load_dwordx4 v[92:95], v1, s[36:39], s62 offen offset:3072 nt
    s_waitcnt vmcnt(3)
    s_add_u32 s62, s62, 0x20000
    s_and_b32 s62, s62, 0xfffff
    buffer_load_dwordx4 v[96:99], v1, s[36:39], s62 offen offset:0 nt
    s_waitcnt vmcnt(3)
    buffer_load_dwordx4 v[100:103], v1, s[36:39], s62 offen offset:1024 nt
    s_waitcnt vmcnt(3)
    buffer_load_dwordx4 v[104:107], v1, s[36:39], s62 offen offset:2048 nt
    s_waitcnt vmcnt(3)
    buffer_load_dwordx4 v[108:111], v1, s[36:39], s62 offen offset:3072 nt
    s_waitcnt vmcnt(3)
    s_add_u32 s62, s62, 0x20000
    s_and_b32 s62, s62, 0xfffff
    buffer_load_dwordx4 v[112:115], v1, s[36:39], s62 offen offset:0 nt
    s_waitcnt vmcnt(3)
    buffer_load_dwordx4 v[116:119], v1, s[36:39], s62 offen offset:1024 nt
    s_waitcnt vmcnt(3)
    buffer_load_dwordx4 v[120:123], v1, s[36:39], s62 offen offset:2048 nt
    s_waitcnt vmcnt(3)
    buffer_load_dwordx4 v[124:127], v1, s[36:39], s62 offen offset:3072 nt
    s_waitcnt vmcnt(3)
    s_add_u32 s62, s62, 0x20000
    s_and_b32 s62, s62, 0xfffff
    buffer_load_dwordx4 v[128:131], v1, s[36:39], s62 offen offset:0 nt
    s_waitcnt vmcnt(3)
    buffer_load_dwordx4 v[132:135], v1, s[36:39], s62 offen offset:1024 nt
    s_waitcnt vmcnt(3)
    buffer_load_dwordx4 v[136:139], v1, s[36:39], s62 offen offset:2048 nt
    s_waitcnt vmcnt(3)
    buffer_load_dwordx4 v[140:143], v1, s[36:39], s62 offen offset:3072 nt
    s_waitcnt vmcnt(3)
    s_add_u32 s62, s62, 0x20000
    s_and_b32 s62, s62, 0xfffff
    buffer_load_dwordx4 v[144:147], v1, s[36:39], s62 offen offset:0 nt
    s_waitcnt vmcnt(3)
    buffer_load_dwordx4 v[148:151], v1, s[36:39], s62 offen offset:1024 nt
    s_waitcnt vmcnt(3)
    buffer_load_dwordx4 v[152:155], v1, s[36:39], s62 offen offset:2048 nt
    s_waitcnt vmcnt(3)
    buffer_load_dwordx4 v[156:159], v1, s[36:39], s62 offen offset:3072 nt
    v_lshrrev_b32 v5, 5, v23
    v_lshlrev_b32 v5, 9, v5
    v_add_u32 v5, v5, v2
    s_lshl_b32 s34, s34, 10
    s_lshl_b32 s35, s69, 9
    s_add_u32 s34, s34, s35
    s_add_u32 s34, s34, 0x120000
    s_add_u32 s35, s34, 4096
    buffer_load_dwordx4 v[46:49], v5, s[56:59], s34 offen offset:0 sc1
    buffer_load_dwordx4 v[50:53], v5, s[56:59], s34 offen offset:2048 sc1
    buffer_load_dwordx4 v[54:57], v5, s[56:59], s35 offen offset:0 sc1
    buffer_load_dwordx4 v[58:61], v5, s[56:59], s35 offen offset:2048 sc1
    s_waitcnt vmcnt(7)
    s_add_u32 s62, s62, 0x20000
    s_and_b32 s62, s62, 0xfffff
    buffer_load_dwordx4 v[160:163], v1, s[36:39], s62 offen offset:0 nt
    s_waitcnt vmcnt(7)
    buffer_load_dwordx4 v[164:167], v1, s[36:39], s62 offen offset:1024 nt
    s_waitcnt vmcnt(7)
    buffer_load_dwordx4 v[168:171], v1, s[36:39], s62 offen offset:2048 nt
    s_waitcnt vmcnt(7)
    buffer_load_dwordx4 v[172:175], v1, s[36:39], s62 offen offset:3072 nt
    s_mov_b32 s32, 0x0c0c0400
    s_mov_b32 s33, 0x04000c0c
    s_waitcnt vmcnt(4)
    v_perm_b32 v14, v47, v46, s32
    v_perm_b32 v15, v49, v48, s33
    v_or_b32 v14, v14, v15
    v_cmp_eq_u32 vcc, s90, v14
    v_perm_b32 v14, v51, v50, s32
    v_perm_b32 v15, v53, v52, s33
    v_or_b32 v14, v14, v15
    v_cmp_eq_u32 s[92:93], s90, v14
    s_and_b64 vcc, vcc, s[92:93]
    v_perm_b32 v14, v55, v54, s32
    v_perm_b32 v15, v57, v56, s33
    v_or_b32 v14, v14, v15
    v_cmp_eq_u32 s[92:93], s90, v14
    s_and_b64 vcc, vcc, s[92:93]
    v_perm_b32 v14, v59, v58, s32
    v_perm_b32 v15, v61, v60, s33
    v_or_b32 v14, v14, v15
    v_cmp_eq_u32 s[92:93], s90, v14
    s_and_b64 vcc, vcc, s[92:93]
    s_cmp_eq_u64 vcc, -1
    s_cbranch_scc1 L_p1_x
    s_mov_b32 s89, 0
L_p1:
    buffer_load_dwordx4 v[46:49], v5, s[56:59], s34 offen offset:0 sc1
    buffer_load_dwordx4 v[50:53], v5, s[56:59], s34 offen offset:2048 sc1
    buffer_load_dwordx4 v[54:57], v5, s[56:59], s35 offen offset:0 sc1
    buffer_load_dwordx4 v[58:61], v5, s[56:59], s35 offen offset:2048 sc1
    s_add_u32 s89, s89, 1
    s_mov_b32 s32, 0x0c0c0400
    s_mov_b32 s33, 0x04000c0c
    s_waitcnt vmcnt(0)
    v_perm_b32 v14, v47, v46, s32
    v_perm_b32 v15, v49, v48, s33
    v_or_b32 v14, v14, v15
    v_cmp_eq_u32 vcc, s90, v14
    v_perm_b32 v14, v51, v50, s32
    v_perm_b32 v15, v53, v52, s33
    v_or_b32 v14, v14, v15
    v_cmp_eq_u32 s[92:93], s90, v14
    s_and_b64 vcc, vcc, s[92:93]
    v_perm_b32 v14, v55, v54, s32
    v_perm_b32 v15, v57, v56, s33
    v_or_b32 v14, v14, v15
    v_cmp_eq_u32 s[92:93], s90, v14
    s_and_b64 vcc, vcc, s[92:93]
    v_perm_b32 v14, v59, v58, s32
    v_perm_b32 v15, v61, v60, s33
    v_or_b32 v14, v14, v15
    v_cmp_eq_u32 s[92:93], s90, v14
    s_and_b64 vcc, vcc, s[92:93]
    s_cmp_eq_u64 vcc, -1
    s_cbranch_scc1 L_p1_x
    s_cmp_ge_u32 s89, 0x40000
    s_cbranch_scc1 L_p1_x
    s_sleep 32
    s_branch L_p1
L_p1_x:
    v_lshlrev_b32 v5, 3, v23
    v_and_b32 v46, 0xffffff00, v46
    v_and_b32 v47, 0xffffff00, v47
    v_and_b32 v48, 0xffffff00, v48
    v_and_b32 v49, 0xffffff00, v49
    v_and_b32 v50, 0xffffff00, v50
    v_and_b32 v51, 0xffffff00, v51
    v_and_b32 v52, 0xffffff00, v52
    v_and_b32 v53, 0xffffff00, v53
    v_and_b32 v54, 0xffffff00, v54
    v_and_b32 v55, 0xffffff00, v55
    v_and_b32 v56, 0xffffff00, v56
    v_and_b32 v57, 0xffffff00, v57
    v_and_b32 v58, 0xffffff00, v58
    v_and_b32 v59, 0xffffff00, v59
    v_and_b32 v60, 0xffffff00, v60
    v_and_b32 v61, 0xffffff00, v61
    v_add_f32 v46, v46, v50
    v_add_f32 v54, v54, v58
    v_add_f32 v47, v47, v51
    v_add_f32 v55, v55, v59
    v_add_f32 v48, v48, v52
    v_add_f32 v56, v56, v60
    v_add_f32 v49, v49, v53
    v_add_f32 v57, v57, v61
    v_add_f32 v46, v46, v54
    v_add_f32 v47, v47, v55
    v_add_f32 v48, v48, v56
    v_add_f32 v49, v49, v57
    v_cvt_pk_bf16_f32 v46, v46, v47
    v_cvt_pk_bf16_f32 v47, v48, v49
    ds_write_b64 v5, v[46:47] offset:0
    v_mov_b32 v14, 0
    v_mov_b32 v15, s90
    s_waitcnt lgkmcnt(0)
    ds_write_b32 v14, v15 offset:512
    s_add_u32 s62, s62, 0x20000
    s_and_b32 s62, s62, 0xfffff
    buffer_load_dwordx4 v[176:179], v1, s[36:39], s62 offen offset:0 nt
    buffer_load_dwordx4 v[180:183], v1, s[36:39], s62 offen offset:1024 nt
    s_waitcnt vmcnt(5)
    buffer_load_dwordx4 v[184:187], v1, s[36:39], s62 offen offset:2048 nt
    s_waitcnt vmcnt(5)
    buffer_load_dwordx4 v[188:191], v1, s[36:39], s62 offen offset:3072 nt
    s_waitcnt vmcnt(5)
    s_add_u32 s62, s62, 0x20000
    s_and_b32 s62, s62, 0xfffff
    buffer_load_dwordx4 v[192:195], v1, s[36:39], s62 offen offset:0 nt
    s_waitcnt vmcnt(5)
    buffer_load_dwordx4 v[196:199], v1, s[36:39], s62 offen offset:1024 nt
    s_waitcnt vmcnt(5)
    buffer_load_dwordx4 v[200:203], v1, s[36:39], s62 offen offset:2048 nt
    s_waitcnt vmcnt(5)
    buffer_load_dwordx4 v[204:207], v1, s[36:39], s62 offen offset:3072 nt
    s_waitcnt vmcnt(5)
    buffer_load_dwordx4 v[208:211], v2, s[40:43], s63 offen offset:0 nt
    s_waitcnt vmcnt(5)
    buffer_load_dwordx4 v[212:215], v2, s[40:43], s63 offen offset:1024 nt
    s_waitcnt vmcnt(5)
    buffer_load_dwordx4 v[216:219], v2, s[40:43], s63 offen offset:2048 nt
    s_waitcnt vmcnt(5)
    buffer_load_dwordx4 v[220:223], v2, s[40:43], s63 offen offset:3072 nt
    s_waitcnt vmcnt(5)
    s_add_u32 s63, s63, 0x20000
    s_and_b32 s63, s63, 0xfffff
    buffer_load_dwordx4 v[224:227], v2, s[40:43], s63 offen offset:0 nt
    s_waitcnt vmcnt(5)
    buffer_load_dwordx4 v[228:231], v2, s[40:43], s63 offen offset:1024 nt
    s_waitcnt vmcnt(5)
    buffer_load_dwordx4 v[232:235], v2, s[40:43], s63 offen offset:2048 nt
    s_waitcnt vmcnt(5)
    buffer_load_dwordx4 v[236:239], v2, s[40:43], s63 offen offset:3072 nt
    s_waitcnt vmcnt(3)
    s_branch L_join
L_strm:
    s_barrier
    buffer_load_dwordx4 v[80:83], v1, s[36:39], s62 offen offset:0 nt
    buffer_load_dwordx4 v[84:87], v1, s[36:39], s62 offen offset:1024 nt
    buffer_load_dwordx4 v[88:91], v1, s[36:39], s62 offen offset:2048 nt
    s_mov_b32 s66, 0x3db504f3
    s_mov_b32 s67, 0x3fb8aa3b
    s_movk_i32 s65, 4608
    v_lshrrev_b32 v26, 3, v23
    v_and_b32 v27, 7, v23
    v_and_b32 v28, 1, v27
    v_lshlrev_b32 v28, 4, v28
    v_mov_b32 v29, 0xffff
    v_lshlrev_b32 v28, v28, v29
    v_lshrrev_b32 v29, 1, v27
    v_cmp_eq_u32 vcc, 0, v29
    s_nop 1
    v_cndmask_b32 v6, 0, v28, vcc
    v_cmp_eq_u32 vcc, 1, v29
    s_nop 1
    v_cndmask_b32 v7, 0, v28, vcc
    v_cmp_eq_u32 vcc, 2, v29
    s_nop 1
    v_cndmask_b32 v8, 0, v28, vcc
    v_cmp_eq_u32 vcc, 3, v29
    s_nop 1
    v_cndmask_b32 v9, 0, v28, vcc
    v_and_b32 v26, 1, v26
    v_lshrrev_b32 v28, 1, v24
    v_lshlrev_b32 v28, 9, v28
    v_lshl_add_u32 v28, v25, 5, v28
    v_and_b32 v29, 1, v24
    v_lshl_add_u32 v28, v29, 4, v28
    v_mul_u32_u24 v4, 9216, v24
    v_subrev_u32 v29, 3, v22
    v_lshlrev_b32 v29, 4, v29
    v_add_u32 v29, v29, v25
    v_lshl_add_u32 v4, v29, 4, v4
    v_cmp_gt_u32 vcc, 72, v29
    v_mov_b32 v27, 0x7ff00000
    s_nop 0
    v_cndmask_b32 v4, v27, v4, vcc
    v_lshrrev_b32 v5, 1, v24
    v_mul_u32_u24 v5, 294912, v5
    v_lshl_add_u32 v5, v25, 4, v5
    s_sub_u32 s32, s60, 3
    s_lshl_b32 s32, s32, 9
    s_cmp_eq_u32 s60, 7
    s_cselect_b32 s33, 7, 8
    v_and_b32 v29, 1, v24
    v_lshlrev_b32 v29, s33, v29
    v_add3_u32 v5, v29, s32, v5
    v_cndmask_b32 v27, v27, v5, vcc
    s_waitcnt vmcnt(2)
    buffer_load_dwordx4 v[92:95], v1, s[36:39], s62 offen offset:3072 nt
    s_waitcnt vmcnt(2)
    s_add_u32 s62, s62, 0x20000
    s_and_b32 s62, s62, 0xfffff
    buffer_load_dwordx4 v[96:99], v1, s[36:39], s62 offen offset:0 nt
    s_waitcnt vmcnt(2)
    buffer_load_dwordx4 v[100:103], v1, s[36:39], s62 offen offset:1024 nt
    s_waitcnt vmcnt(2)
    buffer_load_dwordx4 v[104:107], v1, s[36:39], s62 offen offset:2048 nt
    s_waitcnt vmcnt(2)
    buffer_load_dwordx4 v[108:111], v1, s[36:39], s62 offen offset:3072 nt
    s_add_u32 s62, s62, 0x20000
    s_and_b32 s62, s62, 0xfffff
    buffer_load_dwordx4 v[112:115], v1, s[36:39], s62 offen offset:0 nt
    s_waitcnt vmcnt(3)
    buffer_load_dwordx4 v[116:119], v1, s[36:39], s62 offen offset:1024 nt
    s_waitcnt vmcnt(3)
    buffer_load_dwordx4 v[120:123], v1, s[36:39], s62 offen offset:2048 nt
    s_waitcnt vmcnt(3)
    buffer_load_dwordx4 v[124:127], v1, s[36:39], s62 offen offset:3072 nt
    s_waitcnt vmcnt(3)
    s_add_u32 s62, s62, 0x20000
    s_and_b32 s62, s62, 0xfffff
    buffer_load_dwordx4 v[128:131], v1, s[36:39], s62 offen offset:0 nt
    s_waitcnt vmcnt(3)
    buffer_load_dwordx4 v[132:135], v1, s[36:39], s62 offen offset:1024 nt
    s_waitcnt vmcnt(3)
    buffer_load_dwordx4 v[136:139], v1, s[36:39], s62 offen offset:2048 nt
    s_waitcnt vmcnt(3)
    buffer_load_dwordx4 v[140:143], v1, s[36:39], s62 offen offset:3072 nt
    s_waitcnt vmcnt(3)
    s_add_u32 s62, s62, 0x20000
    s_and_b32 s62, s62, 0xfffff
    buffer_load_dwordx4 v[144:147], v1, s[36:39], s62 offen offset:0 nt
    s_waitcnt vmcnt(3)
    buffer_load_dwordx4 v[148:151], v1, s[36:39], s62 offen offset:1024 nt
    s_waitcnt vmcnt(3)
    buffer_load_dwordx4 v[152:155], v1, s[36:39], s62 offen offset:2048 nt
    s_waitcnt vmcnt(3)
    buffer_load_dwordx4 v[156:159], v1, s[36:39], s62 offen offset:3072 nt
    s_waitcnt vmcnt(3)
    s_add_u32 s62, s62, 0x20000
    s_and_b32 s62, s62, 0xfffff
    buffer_load_dwordx4 v[160:163], v1, s[36:39], s62 offen offset:0 nt
    s_waitcnt vmcnt(3)
    buffer_load_dwordx4 v[164:167], v1, s[36:39], s62 offen offset:1024 nt
    s_waitcnt vmcnt(3)
    buffer_load_dwordx4 v[168:171], v1, s[36:39], s62 offen offset:2048 nt
    s_waitcnt vmcnt(3)
    buffer_load_dwordx4 v[172:175], v1, s[36:39], s62 offen offset:3072 nt
    s_waitcnt vmcnt(3)
    s_add_u32 s62, s62, 0x20000
    s_and_b32 s62, s62, 0xfffff
    buffer_load_dwordx4 v[176:179], v1, s[36:39], s62 offen offset:0 nt
    s_waitcnt vmcnt(3)
    buffer_load_dwordx4 v[180:183], v1, s[36:39], s62 offen offset:1024 nt
    s_waitcnt vmcnt(3)
    buffer_load_dwordx4 v[184:187], v1, s[36:39], s62 offen offset:2048 nt
    s_waitcnt vmcnt(3)
    buffer_load_dwordx4 v[188:191], v1, s[36:39], s62 offen offset:3072 nt
    s_waitcnt vmcnt(3)
    s_add_u32 s62, s62, 0x20000
    s_and_b32 s62, s62, 0xfffff
    buffer_load_dwordx4 v[192:195], v1, s[36:39], s62 offen offset:0 nt
    s_waitcnt vmcnt(3)
    buffer_load_dwordx4 v[196:199], v1, s[36:39], s62 offen offset:1024 nt
    s_waitcnt vmcnt(3)
    buffer_load_dwordx4 v[200:203], v1, s[36:39], s62 offen offset:2048 nt
    s_waitcnt vmcnt(3)
    buffer_load_dwordx4 v[204:207], v1, s[36:39], s62 offen offset:3072 nt
    s_waitcnt vmcnt(3)
    buffer_load_dwordx4 v[208:211], v2, s[40:43], s63 offen offset:0 nt
    s_waitcnt vmcnt(3)
    buffer_load_dwordx4 v[212:215], v2, s[40:43], s63 offen offset:1024 nt
    s_waitcnt vmcnt(3)
    buffer_load_dwordx4 v[216:219], v2, s[40:43], s63 offen offset:2048 nt
    s_waitcnt vmcnt(3)
    buffer_load_dwordx4 v[220:223], v2, s[40:43], s63 offen offset:3072 nt
    s_waitcnt vmcnt(3)
    s_add_u32 s63, s63, 0x20000
    s_and_b32 s63, s63, 0xfffff
    buffer_load_dwordx4 v[224:227], v2, s[40:43], s63 offen offset:0 nt
    s_waitcnt vmcnt(3)
    buffer_load_dwordx4 v[228:231], v2, s[40:43], s63 offen offset:1024 nt
    s_waitcnt vmcnt(3)
    buffer_load_dwordx4 v[232:235], v2, s[40:43], s63 offen offset:2048 nt
    s_waitcnt vmcnt(3)
    buffer_load_dwordx4 v[236:239], v2, s[40:43], s63 offen offset:3072 nt
    v_mov_b32 v14, 0
    s_mov_b32 s89, 0
L_pf:
    ds_read_b32 v15, v14 offset:512
    s_add_u32 s89, s89, 1
    s_waitcnt lgkmcnt(0)
    v_readfirstlane_b32 s90, v15
    s_cmp_lg_u32 s90, 0
    s_cbranch_scc1 L_pf_x
    s_cmp_ge_u32 s89, 0x40000
    s_cbranch_scc1 L_pf_x
    s_sleep 2
    s_branch L_pf
L_pf_x:
L_join:
    v_lshlrev_b32 v5, 8, v26
    v_lshl_add_u32 v5, v24, 6, v5
    v_and_b32 v14, 3, v23
    v_lshl_add_u32 v5, v14, 4, v5
    ds_read_b128 v[38:41], v5 offset:0
    v_and_b32 v14, 4, v23
    v_cmp_eq_u32 vcc, 0, v14
    s_waitcnt lgkmcnt(0)
    v_cndmask_b32 v30, 0, v38, vcc
    v_cndmask_b32 v31, 0, v39, vcc
    v_cndmask_b32 v32, 0, v40, vcc
    v_cndmask_b32 v33, 0, v41, vcc
    v_xor_b32 v34, v30, v38
    v_xor_b32 v35, v31, v39
    v_xor_b32 v36, v32, v40
    v_xor_b32 v37, v33, v41
    s_nop 0
    v_mfma_f32_16x16x32_bf16 v[62:65], v[80:83], v[30:33], 0
    v_mfma_f32_16x16x32_bf16 v[66:69], v[88:91], v[30:33], 0
    v_mfma_f32_16x16x32_bf16 v[62:65], v[84:87], v[34:37], v[62:65]
    v_mfma_f32_16x16x32_bf16 v[66:69], v[92:95], v[34:37], v[66:69]
    v_mfma_f32_16x16x32_bf16 v[70:73], v[96:99], v[30:33], 0
    v_mfma_f32_16x16x32_bf16 v[74:77], v[104:107], v[30:33], 0
    v_mfma_f32_16x16x32_bf16 v[70:73], v[100:103], v[34:37], v[70:73]
    v_mfma_f32_16x16x32_bf16 v[74:77], v[108:111], v[34:37], v[74:77]
    s_nop 7
    v_mov_b32_dpp v46, v62 quad_perm:[0,0,0,0] row_mask:0xf bank_mask:0xf
    v_mov_b32_dpp v47, v66 quad_perm:[0,0,0,0] row_mask:0xf bank_mask:0xf
    v_add_f32_dpp v46, v63, v46 quad_perm:[1,1,1,1] row_mask:0xf bank_mask:0xf
    v_add_f32_dpp v47, v67, v47 quad_perm:[1,1,1,1] row_mask:0xf bank_mask:0xf
    v_add_f32_dpp v46, v64, v46 quad_perm:[2,2,2,2] row_mask:0xf bank_mask:0xf
    v_add_f32_dpp v47, v68, v47 quad_perm:[2,2,2,2] row_mask:0xf bank_mask:0xf
    v_add_f32_dpp v46, v65, v46 quad_perm:[3,3,3,3] row_mask:0xf bank_mask:0xf
    v_add_f32_dpp v47, v69, v47 quad_perm:[3,3,3,3] row_mask:0xf bank_mask:0xf
    v_cvt_pk_bf16_f32 v47, v46, v47
    v_lshlrev_b32 v46, 16, v47
    v_and_b32 v47, 0xffff0000, v47
    v_mul_f32 v46, s66, v46
    v_mul_f32 v47, s66, v47
    v_cvt_pk_bf16_f32 v47, v46, v47
    v_lshlrev_b32 v46, 16, v47
    v_and_b32 v47, 0xffff0000, v47
    v_max_f32 v78, v46, v47
    v_mfma_f32_16x16x32_bf16 v[62:65], v[112:115], v[30:33], 0
    v_mfma_f32_16x16x32_bf16 v[66:69], v[120:123], v[30:33], 0
    v_mfma_f32_16x16x32_bf16 v[62:65], v[116:119], v[34:37], v[62:65]
    v_mfma_f32_16x16x32_bf16 v[66:69], v[124:127], v[34:37], v[66:69]
    s_nop 7
    v_mov_b32_dpp v48, v70 quad_perm:[0,0,0,0] row_mask:0xf bank_mask:0xf
    v_mov_b32_dpp v49, v74 quad_perm:[0,0,0,0] row_mask:0xf bank_mask:0xf
    v_add_f32_dpp v48, v71, v48 quad_perm:[1,1,1,1] row_mask:0xf bank_mask:0xf
    v_add_f32_dpp v49, v75, v49 quad_perm:[1,1,1,1] row_mask:0xf bank_mask:0xf
    v_add_f32_dpp v48, v72, v48 quad_perm:[2,2,2,2] row_mask:0xf bank_mask:0xf
    v_add_f32_dpp v49, v76, v49 quad_perm:[2,2,2,2] row_mask:0xf bank_mask:0xf
    v_add_f32_dpp v48, v73, v48 quad_perm:[3,3,3,3] row_mask:0xf bank_mask:0xf
    v_add_f32_dpp v49, v77, v49 quad_perm:[3,3,3,3] row_mask:0xf bank_mask:0xf
    v_cvt_pk_bf16_f32 v49, v48, v49
    v_lshlrev_b32 v48, 16, v49
    v_and_b32 v49, 0xffff0000, v49
    v_mul_f32 v48, s66, v48
    v_mul_f32 v49, s66, v49
    v_cvt_pk_bf16_f32 v49, v48, v49
    v_lshlrev_b32 v48, 16, v49
    v_and_b32 v49, 0xffff0000, v49
    v_max3_f32 v78, v78, v48, v49
    v_mfma_f32_16x16x32_bf16 v[70:73], v[128:131], v[30:33], 0
    v_mfma_f32_16x16x32_bf16 v[74:77], v[136:139], v[30:33], 0
    v_mfma_f32_16x16x32_bf16 v[70:73], v[132:135], v[34:37], v[70:73]
    v_mfma_f32_16x16x32_bf16 v[74:77], v[140:143], v[34:37], v[74:77]
    s_nop 7
    v_mov_b32_dpp v50, v62 quad_perm:[0,0,0,0] row_mask:0xf bank_mask:0xf
    v_mov_b32_dpp v51, v66 quad_perm:[0,0,0,0] row_mask:0xf bank_mask:0xf
    v_add_f32_dpp v50, v63, v50 quad_perm:[1,1,1,1] row_mask:0xf bank_mask:0xf
    v_add_f32_dpp v51, v67, v51 quad_perm:[1,1,1,1] row_mask:0xf bank_mask:0xf
    v_add_f32_dpp v50, v64, v50 quad_perm:[2,2,2,2] row_mask:0xf bank_mask:0xf
    v_add_f32_dpp v51, v68, v51 quad_perm:[2,2,2,2] row_mask:0xf bank_mask:0xf
    v_add_f32_dpp v50, v65, v50 quad_perm:[3,3,3,3] row_mask:0xf bank_mask:0xf
    v_add_f32_dpp v51, v69, v51 quad_perm:[3,3,3,3] row_mask:0xf bank_mask:0xf
    v_cvt_pk_bf16_f32 v51, v50, v51
    v_lshlrev_b32 v50, 16, v51
    v_and_b32 v51, 0xffff0000, v51
    v_mul_f32 v50, s66, v50
    v_mul_f32 v51, s66, v51
    v_cvt_pk_bf16_f32 v51, v50, v51
    v_lshlrev_b32 v50, 16, v51
    v_and_b32 v51, 0xffff0000, v51
    v_max3_f32 v78, v78, v50, v51
    v_mfma_f32_16x16x32_bf16 v[62:65], v[144:147], v[30:33], 0
    v_mfma_f32_16x16x32_bf16 v[66:69], v[152:155], v[30:33], 0
    v_mfma_f32_16x16x32_bf16 v[62:65], v[148:151], v[34:37], v[62:65]
    v_mfma_f32_16x16x32_bf16 v[66:69], v[156:159], v[34:37], v[66:69]
    s_nop 7
    v_mov_b32_dpp v52, v70 quad_perm:[0,0,0,0] row_mask:0xf bank_mask:0xf
    v_mov_b32_dpp v53, v74 quad_perm:[0,0,0,0] row_mask:0xf bank_mask:0xf
    v_add_f32_dpp v52, v71, v52 quad_perm:[1,1,1,1] row_mask:0xf bank_mask:0xf
    v_add_f32_dpp v53, v75, v53 quad_perm:[1,1,1,1] row_mask:0xf bank_mask:0xf
    v_add_f32_dpp v52, v72, v52 quad_perm:[2,2,2,2] row_mask:0xf bank_mask:0xf
    v_add_f32_dpp v53, v76, v53 quad_perm:[2,2,2,2] row_mask:0xf bank_mask:0xf
    v_add_f32_dpp v52, v73, v52 quad_perm:[3,3,3,3] row_mask:0xf bank_mask:0xf
    v_add_f32_dpp v53, v77, v53 quad_perm:[3,3,3,3] row_mask:0xf bank_mask:0xf
    v_cvt_pk_bf16_f32 v53, v52, v53
    v_lshlrev_b32 v52, 16, v53
    v_and_b32 v53, 0xffff0000, v53
    v_mul_f32 v52, s66, v52
    v_mul_f32 v53, s66, v53
    v_cvt_pk_bf16_f32 v53, v52, v53
    v_lshlrev_b32 v52, 16, v53
    v_and_b32 v53, 0xffff0000, v53
    v_max3_f32 v78, v78, v52, v53
    v_mfma_f32_16x16x32_bf16 v[70:73], v[160:163], v[30:33], 0
    v_mfma_f32_16x16x32_bf16 v[74:77], v[168:171], v[30:33], 0
    v_mfma_f32_16x16x32_bf16 v[70:73], v[164:167], v[34:37], v[70:73]
    v_mfma_f32_16x16x32_bf16 v[74:77], v[172:175], v[34:37], v[74:77]
    s_nop 7
    v_mov_b32_dpp v54, v62 quad_perm:[0,0,0,0] row_mask:0xf bank_mask:0xf
    v_mov_b32_dpp v55, v66 quad_perm:[0,0,0,0] row_mask:0xf bank_mask:0xf
    v_add_f32_dpp v54, v63, v54 quad_perm:[1,1,1,1] row_mask:0xf bank_mask:0xf
    v_add_f32_dpp v55, v67, v55 quad_perm:[1,1,1,1] row_mask:0xf bank_mask:0xf
    v_add_f32_dpp v54, v64, v54 quad_perm:[2,2,2,2] row_mask:0xf bank_mask:0xf
    v_add_f32_dpp v55, v68, v55 quad_perm:[2,2,2,2] row_mask:0xf bank_mask:0xf
    v_add_f32_dpp v54, v65, v54 quad_perm:[3,3,3,3] row_mask:0xf bank_mask:0xf
    v_add_f32_dpp v55, v69, v55 quad_perm:[3,3,3,3] row_mask:0xf bank_mask:0xf
    v_cvt_pk_bf16_f32 v55, v54, v55
    v_lshlrev_b32 v54, 16, v55
    v_and_b32 v55, 0xffff0000, v55
    v_mul_f32 v54, s66, v54
    v_mul_f32 v55, s66, v55
    v_cvt_pk_bf16_f32 v55, v54, v55
    v_lshlrev_b32 v54, 16, v55
    v_and_b32 v55, 0xffff0000, v55
    v_max3_f32 v78, v78, v54, v55
    v_mfma_f32_16x16x32_bf16 v[62:65], v[176:179], v[30:33], 0
    v_mfma_f32_16x16x32_bf16 v[66:69], v[184:187], v[30:33], 0
    v_mfma_f32_16x16x32_bf16 v[62:65], v[180:183], v[34:37], v[62:65]
    v_mfma_f32_16x16x32_bf16 v[66:69], v[188:191], v[34:37], v[66:69]
    s_nop 7
    v_mov_b32_dpp v56, v70 quad_perm:[0,0,0,0] row_mask:0xf bank_mask:0xf
    v_mov_b32_dpp v57, v74 quad_perm:[0,0,0,0] row_mask:0xf bank_mask:0xf
    v_add_f32_dpp v56, v71, v56 quad_perm:[1,1,1,1] row_mask:0xf bank_mask:0xf
    v_add_f32_dpp v57, v75, v57 quad_perm:[1,1,1,1] row_mask:0xf bank_mask:0xf
    v_add_f32_dpp v56, v72, v56 quad_perm:[2,2,2,2] row_mask:0xf bank_mask:0xf
    v_add_f32_dpp v57, v76, v57 quad_perm:[2,2,2,2] row_mask:0xf bank_mask:0xf
    v_add_f32_dpp v56, v73, v56 quad_perm:[3,3,3,3] row_mask:0xf bank_mask:0xf
    v_add_f32_dpp v57, v77, v57 quad_perm:[3,3,3,3] row_mask:0xf bank_mask:0xf
    v_cvt_pk_bf16_f32 v57, v56, v57
    v_lshlrev_b32 v56, 16, v57
    v_and_b32 v57, 0xffff0000, v57
    v_mul_f32 v56, s66, v56
    v_mul_f32 v57, s66, v57
    v_cvt_pk_bf16_f32 v57, v56, v57
    v_lshlrev_b32 v56, 16, v57
    v_and_b32 v57, 0xffff0000, v57
    v_max3_f32 v78, v78, v56, v57
    v_mfma_f32_16x16x32_bf16 v[70:73], v[192:195], v[30:33], 0
    v_mfma_f32_16x16x32_bf16 v[74:77], v[200:203], v[30:33], 0
    v_mfma_f32_16x16x32_bf16 v[70:73], v[196:199], v[34:37], v[70:73]
    v_mfma_f32_16x16x32_bf16 v[74:77], v[204:207], v[34:37], v[74:77]
    s_nop 7
    v_mov_b32_dpp v58, v62 quad_perm:[0,0,0,0] row_mask:0xf bank_mask:0xf
    v_mov_b32_dpp v59, v66 quad_perm:[0,0,0,0] row_mask:0xf bank_mask:0xf
    v_add_f32_dpp v58, v63, v58 quad_perm:[1,1,1,1] row_mask:0xf bank_mask:0xf
    v_add_f32_dpp v59, v67, v59 quad_perm:[1,1,1,1] row_mask:0xf bank_mask:0xf
    v_add_f32_dpp v58, v64, v58 quad_perm:[2,2,2,2] row_mask:0xf bank_mask:0xf
    v_add_f32_dpp v59, v68, v59 quad_perm:[2,2,2,2] row_mask:0xf bank_mask:0xf
    v_add_f32_dpp v58, v65, v58 quad_perm:[3,3,3,3] row_mask:0xf bank_mask:0xf
    v_add_f32_dpp v59, v69, v59 quad_perm:[3,3,3,3] row_mask:0xf bank_mask:0xf
    v_cvt_pk_bf16_f32 v59, v58, v59
    v_lshlrev_b32 v58, 16, v59
    v_and_b32 v59, 0xffff0000, v59
    v_mul_f32 v58, s66, v58
    v_mul_f32 v59, s66, v59
    v_cvt_pk_bf16_f32 v59, v58, v59
    v_lshlrev_b32 v58, 16, v59
    v_and_b32 v59, 0xffff0000, v59
    v_max3_f32 v78, v78, v58, v59
    s_nop 7
    s_nop 3
    v_mov_b32_dpp v60, v70 quad_perm:[0,0,0,0] row_mask:0xf bank_mask:0xf
    v_mov_b32_dpp v61, v74 quad_perm:[0,0,0,0] row_mask:0xf bank_mask:0xf
    v_add_f32_dpp v60, v71, v60 quad_perm:[1,1,1,1] row_mask:0xf bank_mask:0xf
    v_add_f32_dpp v61, v75, v61 quad_perm:[1,1,1,1] row_mask:0xf bank_mask:0xf
    v_add_f32_dpp v60, v72, v60 quad_perm:[2,2,2,2] row_mask:0xf bank_mask:0xf
    v_add_f32_dpp v61, v76, v61 quad_perm:[2,2,2,2] row_mask:0xf bank_mask:0xf
    v_add_f32_dpp v60, v73, v60 quad_perm:[3,3,3,3] row_mask:0xf bank_mask:0xf
    v_add_f32_dpp v61, v77, v61 quad_perm:[3,3,3,3] row_mask:0xf bank_mask:0xf
    v_cvt_pk_bf16_f32 v61, v60, v61
    v_lshlrev_b32 v60, 16, v61
    v_and_b32 v61, 0xffff0000, v61
    v_mul_f32 v60, s66, v60
    v_mul_f32 v61, s66, v61
    v_cvt_pk_bf16_f32 v61, v60, v61
    v_lshlrev_b32 v60, 16, v61
    v_and_b32 v61, 0xffff0000, v61
    v_max3_f32 v78, v78, v60, v61
    s_nop 1
    v_max_f32_dpp v78, v78, v78 row_half_mirror row_mask:0xf bank_mask:0xf
    v_mov_b32 v5, v78
    s_nop 1
    v_permlane32_swap_b32 v78, v5
    s_nop 1
    v_max_f32 v78, v78, v5
    v_mov_b32 v5, v78
    s_nop 1
    v_permlane16_swap_b32 v78, v5
    s_nop 1
    v_max_f32 v78, v78, v5
    v_mul_f32 v78, s67, v78
    v_fma_f32 v46, v46, s67, -v78
    v_fma_f32 v47, v47, s67, -v78
    v_fma_f32 v48, v48, s67, -v78
    v_fma_f32 v49, v49, s67, -v78
    v_fma_f32 v50, v50, s67, -v78
    v_fma_f32 v51, v51, s67, -v78
    v_fma_f32 v52, v52, s67, -v78
    v_fma_f32 v53, v53, s67, -v78
    v_fma_f32 v54, v54, s67, -v78
    v_fma_f32 v55, v55, s67, -v78
    v_fma_f32 v56, v56, s67, -v78
    v_fma_f32 v57, v57, s67, -v78
    v_fma_f32 v58, v58, s67, -v78
    v_fma_f32 v59, v59, s67, -v78
    v_fma_f32 v60, v60, s67, -v78
    v_fma_f32 v61, v61, s67, -v78
    v_exp_f32 v46, v46
    v_exp_f32 v47, v47
    v_exp_f32 v48, v48
    v_exp_f32 v49, v49
    v_exp_f32 v50, v50
    v_exp_f32 v51, v51
    v_exp_f32 v52, v52
    v_exp_f32 v53, v53
    v_exp_f32 v54, v54
    v_exp_f32 v55, v55
    v_exp_f32 v56, v56
    v_exp_f32 v57, v57
    v_exp_f32 v58, v58
    v_exp_f32 v59, v59
    v_exp_f32 v60, v60
    v_exp_f32 v61, v61
    v_add_f32 v79, v46, v47
    v_add_f32 v79, v79, v48
    v_add_f32 v79, v79, v49
    v_add_f32 v79, v79, v50
    v_add_f32 v79, v79, v51
    v_add_f32 v79, v79, v52
    v_add_f32 v79, v79, v53
    v_add_f32 v79, v79, v54
    v_add_f32 v79, v79, v55
    v_add_f32 v79, v79, v56
    v_add_f32 v79, v79, v57
    v_add_f32 v79, v79, v58
    v_add_f32 v79, v79, v59
    v_add_f32 v79, v79, v60
    v_add_f32 v79, v79, v61
    v_cvt_pk_bf16_f32 v46, v46, v46
    v_cvt_pk_bf16_f32 v47, v47, v47
    v_cvt_pk_bf16_f32 v48, v48, v48
    v_cvt_pk_bf16_f32 v49, v49, v49
    v_cvt_pk_bf16_f32 v50, v50, v50
    v_cvt_pk_bf16_f32 v51, v51, v51
    v_cvt_pk_bf16_f32 v52, v52, v52
    v_cvt_pk_bf16_f32 v53, v53, v53
    v_cvt_pk_bf16_f32 v54, v54, v54
    v_cvt_pk_bf16_f32 v55, v55, v55
    v_cvt_pk_bf16_f32 v56, v56, v56
    v_cvt_pk_bf16_f32 v57, v57, v57
    v_cvt_pk_bf16_f32 v58, v58, v58
    v_cvt_pk_bf16_f32 v59, v59, v59
    v_cvt_pk_bf16_f32 v60, v60, v60
    v_cvt_pk_bf16_f32 v61, v61, v61
    s_nop 1
    v_add_f32_dpp v79, v79, v79 row_half_mirror row_mask:0xf bank_mask:0xf
    v_mov_b32 v5, v79
    s_nop 1
    v_permlane32_swap_b32 v79, v5
    s_nop 1
    v_add_f32 v79, v79, v5
    v_mov_b32 v5, v79
    s_nop 1
    v_permlane16_swap_b32 v79, v5
    s_nop 1
    v_add_f32 v79, v79, v5
    v_lshlrev_b32 v5, 5, v26
    v_lshl_add_u32 v5, v22, 2, v5
    ds_write_b32 v5, v78 offset:9216
    ds_write_b32 v5, v79 offset:9280
    v_and_b32 v14, v46, v6
    v_and_b32 v15, v46, v7
    v_and_b32_dpp v16, v46, v8 row_shr:4 row_mask:0xf bank_mask:0xf bound_ctrl:0
    v_and_b32_dpp v17, v46, v9 row_shr:4 row_mask:0xf bank_mask:0xf bound_ctrl:0
    s_nop 1
    v_mfma_f32_16x16x32_bf16 v[10:13], v[14:17], v[208:211], 0
    v_and_b32_dpp v18, v46, v6 row_shl:4 row_mask:0xf bank_mask:0xf bound_ctrl:0
    v_and_b32_dpp v19, v46, v7 row_shl:4 row_mask:0xf bank_mask:0xf bound_ctrl:0
    v_and_b32 v20, v46, v8
    v_and_b32 v21, v46, v9
    s_nop 1
    v_mfma_f32_16x16x32_bf16 v[10:13], v[18:21], v[212:215], v[10:13]
    v_and_b32 v14, v47, v6
    v_and_b32 v15, v47, v7
    v_and_b32_dpp v16, v47, v8 row_shr:4 row_mask:0xf bank_mask:0xf bound_ctrl:0
    v_and_b32_dpp v17, v47, v9 row_shr:4 row_mask:0xf bank_mask:0xf bound_ctrl:0
    s_nop 1
    v_mfma_f32_16x16x32_bf16 v[10:13], v[14:17], v[216:219], v[10:13]
    v_and_b32_dpp v18, v47, v6 row_shl:4 row_mask:0xf bank_mask:0xf bound_ctrl:0
    v_and_b32_dpp v19, v47, v7 row_shl:4 row_mask:0xf bank_mask:0xf bound_ctrl:0
    v_and_b32 v20, v47, v8
    v_and_b32 v21, v47, v9
    s_nop 1
    v_mfma_f32_16x16x32_bf16 v[10:13], v[18:21], v[220:223], v[10:13]
    v_and_b32 v14, v48, v6
    v_and_b32 v15, v48, v7
    v_and_b32_dpp v16, v48, v8 row_shr:4 row_mask:0xf bank_mask:0xf bound_ctrl:0
    v_and_b32_dpp v17, v48, v9 row_shr:4 row_mask:0xf bank_mask:0xf bound_ctrl:0
    s_waitcnt vmcnt(3)
    s_nop 1
    v_mfma_f32_16x16x32_bf16 v[10:13], v[14:17], v[224:227], v[10:13]
    s_add_u32 s63, s63, 0x20000
    s_and_b32 s63, s63, 0xfffff
    buffer_load_dwordx4 v[240:243], v2, s[40:43], s63 offen offset:0 nt
    v_and_b32_dpp v18, v48, v6 row_shl:4 row_mask:0xf bank_mask:0xf bound_ctrl:0
    v_and_b32_dpp v19, v48, v7 row_shl:4 row_mask:0xf bank_mask:0xf bound_ctrl:0
    v_and_b32 v20, v48, v8
    v_and_b32 v21, v48, v9
    s_waitcnt vmcnt(3)
    s_nop 1
    v_mfma_f32_16x16x32_bf16 v[10:13], v[18:21], v[228:231], v[10:13]
    buffer_load_dwordx4 v[244:247], v2, s[40:43], s63 offen offset:1024 nt
    v_and_b32 v14, v49, v6
    v_and_b32 v15, v49, v7
    v_and_b32_dpp v16, v49, v8 row_shr:4 row_mask:0xf bank_mask:0xf bound_ctrl:0
    v_and_b32_dpp v17, v49, v9 row_shr:4 row_mask:0xf bank_mask:0xf bound_ctrl:0
    s_waitcnt vmcnt(3)
    s_nop 1
    v_mfma_f32_16x16x32_bf16 v[10:13], v[14:17], v[232:235], v[10:13]
    buffer_load_dwordx4 v[248:251], v2, s[40:43], s63 offen offset:2048 nt
    v_and_b32_dpp v18, v49, v6 row_shl:4 row_mask:0xf bank_mask:0xf bound_ctrl:0
    v_and_b32_dpp v19, v49, v7 row_shl:4 row_mask:0xf bank_mask:0xf bound_ctrl:0
    v_and_b32 v20, v49, v8
    v_and_b32 v21, v49, v9
    s_waitcnt vmcnt(3)
    s_nop 1
    v_mfma_f32_16x16x32_bf16 v[10:13], v[18:21], v[236:239], v[10:13]
    buffer_load_dwordx4 v[252:255], v2, s[40:43], s63 offen offset:3072 nt
    v_and_b32 v14, v50, v6
    v_and_b32 v15, v50, v7
    v_and_b32_dpp v16, v50, v8 row_shr:4 row_mask:0xf bank_mask:0xf bound_ctrl:0
    v_and_b32_dpp v17, v50, v9 row_shr:4 row_mask:0xf bank_mask:0xf bound_ctrl:0
    s_waitcnt vmcnt(3)
    s_nop 1
    v_mfma_f32_16x16x32_bf16 v[10:13], v[14:17], v[240:243], v[10:13]
    s_add_u32 s63, s63, 0x20000
    s_and_b32 s63, s63, 0xfffff
    buffer_load_dwordx4 v[80:83], v2, s[40:43], s63 offen offset:0 nt
    v_and_b32_dpp v18, v50, v6 row_shl:4 row_mask:0xf bank_mask:0xf bound_ctrl:0
    v_and_b32_dpp v19, v50, v7 row_shl:4 row_mask:0xf bank_mask:0xf bound_ctrl:0
    v_and_b32 v20, v50, v8
    v_and_b32 v21, v50, v9
    s_waitcnt vmcnt(3)
    s_nop 1
    v_mfma_f32_16x16x32_bf16 v[10:13], v[18:21], v[244:247], v[10:13]
    buffer_load_dwordx4 v[84:87], v2, s[40:43], s63 offen offset:1024 nt
    v_and_b32 v14, v51, v6
    v_and_b32 v15, v51, v7
    v_and_b32_dpp v16, v51, v8 row_shr:4 row_mask:0xf bank_mask:0xf bound_ctrl:0
    v_and_b32_dpp v17, v51, v9 row_shr:4 row_mask:0xf bank_mask:0xf bound_ctrl:0
    s_waitcnt vmcnt(3)
    s_nop 1
    v_mfma_f32_16x16x32_bf16 v[10:13], v[14:17], v[248:251], v[10:13]
    buffer_load_dwordx4 v[88:91], v2, s[40:43], s63 offen offset:2048 nt
    v_and_b32_dpp v18, v51, v6 row_shl:4 row_mask:0xf bank_mask:0xf bound_ctrl:0
    v_and_b32_dpp v19, v51, v7 row_shl:4 row_mask:0xf bank_mask:0xf bound_ctrl:0
    v_and_b32 v20, v51, v8
    v_and_b32 v21, v51, v9
    s_waitcnt vmcnt(3)
    s_nop 1
    v_mfma_f32_16x16x32_bf16 v[10:13], v[18:21], v[252:255], v[10:13]
    buffer_load_dwordx4 v[92:95], v2, s[40:43], s63 offen offset:3072 nt
    v_and_b32 v14, v52, v6
    v_and_b32 v15, v52, v7
    v_and_b32_dpp v16, v52, v8 row_shr:4 row_mask:0xf bank_mask:0xf bound_ctrl:0
    v_and_b32_dpp v17, v52, v9 row_shr:4 row_mask:0xf bank_mask:0xf bound_ctrl:0
    s_waitcnt vmcnt(3)
    s_nop 1
    v_mfma_f32_16x16x32_bf16 v[10:13], v[14:17], v[80:83], v[10:13]
    s_add_u32 s63, s63, 0x20000
    s_and_b32 s63, s63, 0xfffff
    buffer_load_dwordx4 v[96:99], v2, s[40:43], s63 offen offset:0 nt
    v_and_b32_dpp v18, v52, v6 row_shl:4 row_mask:0xf bank_mask:0xf bound_ctrl:0
    v_and_b32_dpp v19, v52, v7 row_shl:4 row_mask:0xf bank_mask:0xf bound_ctrl:0
    v_and_b32 v20, v52, v8
    v_and_b32 v21, v52, v9
    s_waitcnt vmcnt(3)
    s_nop 1
    v_mfma_f32_16x16x32_bf16 v[10:13], v[18:21], v[84:87], v[10:13]
    buffer_load_dwordx4 v[100:103], v2, s[40:43], s63 offen offset:1024 nt
    v_and_b32 v14, v53, v6
    v_and_b32 v15, v53, v7
    v_and_b32_dpp v16, v53, v8 row_shr:4 row_mask:0xf bank_mask:0xf bound_ctrl:0
    v_and_b32_dpp v17, v53, v9 row_shr:4 row_mask:0xf bank_mask:0xf bound_ctrl:0
    s_waitcnt vmcnt(3)
    s_nop 1
    v_mfma_f32_16x16x32_bf16 v[10:13], v[14:17], v[88:91], v[10:13]
    buffer_load_dwordx4 v[104:107], v2, s[40:43], s63 offen offset:2048 nt
    v_and_b32_dpp v18, v53, v6 row_shl:4 row_mask:0xf bank_mask:0xf bound_ctrl:0
    v_and_b32_dpp v19, v53, v7 row_shl:4 row_mask:0xf bank_mask:0xf bound_ctrl:0
    v_and_b32 v20, v53, v8
    v_and_b32 v21, v53, v9
    s_waitcnt vmcnt(3)
    s_nop 1
    v_mfma_f32_16x16x32_bf16 v[10:13], v[18:21], v[92:95], v[10:13]
    buffer_load_dwordx4 v[108:111], v2, s[40:43], s63 offen offset:3072 nt
    v_and_b32 v14, v54, v6
    v_and_b32 v15, v54, v7
    v_and_b32_dpp v16, v54, v8 row_shr:4 row_mask:0xf bank_mask:0xf bound_ctrl:0
    v_and_b32_dpp v17, v54, v9 row_shr:4 row_mask:0xf bank_mask:0xf bound_ctrl:0
    s_waitcnt vmcnt(3)
    s_nop 1
    v_mfma_f32_16x16x32_bf16 v[10:13], v[14:17], v[96:99], v[10:13]
    s_add_u32 s63, s63, 0x20000
    s_and_b32 s63, s63, 0xfffff
    buffer_load_dwordx4 v[112:115], v2, s[40:43], s63 offen offset:0 nt
    v_and_b32_dpp v18, v54, v6 row_shl:4 row_mask:0xf bank_mask:0xf bound_ctrl:0
    v_and_b32_dpp v19, v54, v7 row_shl:4 row_mask:0xf bank_mask:0xf bound_ctrl:0
    v_and_b32 v20, v54, v8
    v_and_b32 v21, v54, v9
    s_waitcnt vmcnt(3)
    s_nop 1
    v_mfma_f32_16x16x32_bf16 v[10:13], v[18:21], v[100:103], v[10:13]
    buffer_load_dwordx4 v[116:119], v2, s[40:43], s63 offen offset:1024 nt
    v_and_b32 v14, v55, v6
    v_and_b32 v15, v55, v7
    v_and_b32_dpp v16, v55, v8 row_shr:4 row_mask:0xf bank_mask:0xf bound_ctrl:0
    v_and_b32_dpp v17, v55, v9 row_shr:4 row_mask:0xf bank_mask:0xf bound_ctrl:0
    s_waitcnt vmcnt(3)
    s_nop 1
    v_mfma_f32_16x16x32_bf16 v[10:13], v[14:17], v[104:107], v[10:13]
    buffer_load_dwordx4 v[120:123], v2, s[40:43], s63 offen offset:2048 nt
    v_and_b32_dpp v18, v55, v6 row_shl:4 row_mask:0xf bank_mask:0xf bound_ctrl:0
    v_and_b32_dpp v19, v55, v7 row_shl:4 row_mask:0xf bank_mask:0xf bound_ctrl:0
    v_and_b32 v20, v55, v8
    v_and_b32 v21, v55, v9
    s_waitcnt vmcnt(3)
    s_nop 1
    v_mfma_f32_16x16x32_bf16 v[10:13], v[18:21], v[108:111], v[10:13]
    buffer_load_dwordx4 v[124:127], v2, s[40:43], s63 offen offset:3072 nt
    v_and_b32 v14, v56, v6
    v_and_b32 v15, v56, v7
    v_and_b32_dpp v16, v56, v8 row_shr:4 row_mask:0xf bank_mask:0xf bound_ctrl:0
    v_and_b32_dpp v17, v56, v9 row_shr:4 row_mask:0xf bank_mask:0xf bound_ctrl:0
    s_waitcnt vmcnt(3)
    s_nop 1
    v_mfma_f32_16x16x32_bf16 v[10:13], v[14:17], v[112:115], v[10:13]
    s_add_u32 s63, s63, 0x20000
    s_and_b32 s63, s63, 0xfffff
    buffer_load_dwordx4 v[128:131], v2, s[40:43], s63 offen offset:0 nt
    v_and_b32_dpp v18, v56, v6 row_shl:4 row_mask:0xf bank_mask:0xf bound_ctrl:0
    v_and_b32_dpp v19, v56, v7 row_shl:4 row_mask:0xf bank_mask:0xf bound_ctrl:0
    v_and_b32 v20, v56, v8
    v_and_b32 v21, v56, v9
    s_waitcnt vmcnt(3)
    s_nop 1
    v_mfma_f32_16x16x32_bf16 v[10:13], v[18:21], v[116:119], v[10:13]
    buffer_load_dwordx4 v[132:135], v2, s[40:43], s63 offen offset:1024 nt
    v_and_b32 v14, v57, v6
    v_and_b32 v15, v57, v7
    v_and_b32_dpp v16, v57, v8 row_shr:4 row_mask:0xf bank_mask:0xf bound_ctrl:0
    v_and_b32_dpp v17, v57, v9 row_shr:4 row_mask:0xf bank_mask:0xf bound_ctrl:0
    s_waitcnt vmcnt(3)
    s_nop 1
    v_mfma_f32_16x16x32_bf16 v[10:13], v[14:17], v[120:123], v[10:13]
    buffer_load_dwordx4 v[136:139], v2, s[40:43], s63 offen offset:2048 nt
    v_and_b32_dpp v18, v57, v6 row_shl:4 row_mask:0xf bank_mask:0xf bound_ctrl:0
    v_and_b32_dpp v19, v57, v7 row_shl:4 row_mask:0xf bank_mask:0xf bound_ctrl:0
    v_and_b32 v20, v57, v8
    v_and_b32 v21, v57, v9
    s_waitcnt vmcnt(3)
    s_nop 1
    v_mfma_f32_16x16x32_bf16 v[10:13], v[18:21], v[124:127], v[10:13]
    buffer_load_dwordx4 v[140:143], v2, s[40:43], s63 offen offset:3072 nt
    v_and_b32 v14, v58, v6
    v_and_b32 v15, v58, v7
    v_and_b32_dpp v16, v58, v8 row_shr:4 row_mask:0xf bank_mask:0xf bound_ctrl:0
    v_and_b32_dpp v17, v58, v9 row_shr:4 row_mask:0xf bank_mask:0xf bound_ctrl:0
    s_waitcnt vmcnt(3)
    s_nop 1
    v_mfma_f32_16x16x32_bf16 v[10:13], v[14:17], v[128:131], v[10:13]
    s_add_u32 s63, s63, 0x20000
    s_and_b32 s63, s63, 0xfffff
    buffer_load_dwordx4 v[144:147], v2, s[40:43], s63 offen offset:0 nt
    v_and_b32_dpp v18, v58, v6 row_shl:4 row_mask:0xf bank_mask:0xf bound_ctrl:0
    v_and_b32_dpp v19, v58, v7 row_shl:4 row_mask:0xf bank_mask:0xf bound_ctrl:0
    v_and_b32 v20, v58, v8
    v_and_b32 v21, v58, v9
    s_waitcnt vmcnt(3)
    s_nop 1
    v_mfma_f32_16x16x32_bf16 v[10:13], v[18:21], v[132:135], v[10:13]
    buffer_load_dwordx4 v[148:151], v2, s[40:43], s63 offen offset:1024 nt
    v_and_b32 v14, v59, v6
    v_and_b32 v15, v59, v7
    v_and_b32_dpp v16, v59, v8 row_shr:4 row_mask:0xf bank_mask:0xf bound_ctrl:0
    v_and_b32_dpp v17, v59, v9 row_shr:4 row_mask:0xf bank_mask:0xf bound_ctrl:0
    s_waitcnt vmcnt(3)
    s_nop 1
    v_mfma_f32_16x16x32_bf16 v[10:13], v[14:17], v[136:139], v[10:13]
    buffer_load_dwordx4 v[152:155], v2, s[40:43], s63 offen offset:2048 nt
    v_and_b32_dpp v18, v59, v6 row_shl:4 row_mask:0xf bank_mask:0xf bound_ctrl:0
    v_and_b32_dpp v19, v59, v7 row_shl:4 row_mask:0xf bank_mask:0xf bound_ctrl:0
    v_and_b32 v20, v59, v8
    v_and_b32 v21, v59, v9
    s_waitcnt vmcnt(3)
    s_nop 1
    v_mfma_f32_16x16x32_bf16 v[10:13], v[18:21], v[140:143], v[10:13]
    buffer_load_dwordx4 v[156:159], v2, s[40:43], s63 offen offset:3072 nt
    v_and_b32 v14, v60, v6
    v_and_b32 v15, v60, v7
    v_and_b32_dpp v16, v60, v8 row_shr:4 row_mask:0xf bank_mask:0xf bound_ctrl:0
    v_and_b32_dpp v17, v60, v9 row_shr:4 row_mask:0xf bank_mask:0xf bound_ctrl:0
    s_waitcnt vmcnt(3)
    s_nop 1
    v_mfma_f32_16x16x32_bf16 v[10:13], v[14:17], v[144:147], v[10:13]
    v_and_b32_dpp v18, v60, v6 row_shl:4 row_mask:0xf bank_mask:0xf bound_ctrl:0
    v_and_b32_dpp v19, v60, v7 row_shl:4 row_mask:0xf bank_mask:0xf bound_ctrl:0
    v_and_b32 v20, v60, v8
    v_and_b32 v21, v60, v9
    s_waitcnt vmcnt(2)
    s_nop 1
    v_mfma_f32_16x16x32_bf16 v[10:13], v[18:21], v[148:151], v[10:13]
    v_and_b32 v14, v61, v6
    v_and_b32 v15, v61, v7
    v_and_b32_dpp v16, v61, v8 row_shr:4 row_mask:0xf bank_mask:0xf bound_ctrl:0
    v_and_b32_dpp v17, v61, v9 row_shr:4 row_mask:0xf bank_mask:0xf bound_ctrl:0
    s_waitcnt vmcnt(1)
    s_nop 1
    v_mfma_f32_16x16x32_bf16 v[10:13], v[14:17], v[152:155], v[10:13]
    v_and_b32_dpp v18, v61, v6 row_shl:4 row_mask:0xf bank_mask:0xf bound_ctrl:0
    v_and_b32_dpp v19, v61, v7 row_shl:4 row_mask:0xf bank_mask:0xf bound_ctrl:0
    v_and_b32 v20, v61, v8
    v_and_b32 v21, v61, v9
    s_waitcnt vmcnt(0)
    s_nop 1
    v_mfma_f32_16x16x32_bf16 v[10:13], v[18:21], v[156:159], v[10:13]
    v_lshl_add_u32 v5, v22, 10, v28
    v_lshlrev_b32 v18, 6, v26
    v_lshl_add_u32 v18, v24, 4, v18
    s_mov_b32 s34, 0x01000100
    s_mov_b32 s35, 0x03020302
    s_nop 3
    ds_write_b128 v5, v[10:13] offset:1024
    s_sub_u32 s3, s60, 3
    s_cmp_gt_u32 s3, 4
    s_cbranch_scc1 L_nowo
    buffer_load_dwordx4 v[160:163], v4, s[48:51], 0 offen offset:0 nt
    buffer_load_dwordx4 v[164:167], v4, s[48:51], 0 offen offset:1152 nt
    buffer_load_dwordx4 v[168:171], v4, s[48:51], 0 offen offset:2304 nt
    buffer_load_dwordx4 v[172:175], v4, s[48:51], 0 offen offset:3456 nt
    buffer_load_dwordx4 v[176:179], v4, s[48:51], s65 offen offset:0 nt
    buffer_load_dwordx4 v[180:183], v4, s[48:51], s65 offen offset:1152 nt
    buffer_load_dwordx4 v[184:187], v4, s[48:51], s65 offen offset:2304 nt
    buffer_load_dwordx4 v[188:191], v4, s[48:51], s65 offen offset:3456 nt
L_nowo:
    s_waitcnt lgkmcnt(0)
    s_barrier
    s_cmp_lg_u32 s60, 0
    s_cbranch_scc1 L_w2
    v_lshrrev_b32 v5, 5, v23
    v_lshlrev_b32 v14, 5, v5
    ds_read_b128 v[30:33], v14 offset:9216
    ds_read_b128 v[34:37], v14 offset:9232
    ds_read_b128 v[38:41], v14 offset:9280
    ds_read_b128 v[42:45], v14 offset:9296
    ds_read_b128 v[46:49], v2 offset:1024
    ds_read_b128 v[50:53], v2 offset:2048
    ds_read_b128 v[54:57], v2 offset:3072
    ds_read_b128 v[58:61], v2 offset:4096
    ds_read_b128 v[62:65], v2 offset:5120
    ds_read_b128 v[66:69], v2 offset:6144
    ds_read_b128 v[70:73], v2 offset:7168
    ds_read_b128 v[74:77], v2 offset:8192
    s_lshl_b32 s6, s61, 14
    s_add_u32 s6, s6, 0x1a0000
    s_lshl_b32 s7, s68, 7
    s_add_u32 s7, s7, s6
    s_lshl_b32 s5, s69, 7
    s_add_u32 s5, s5, s6
    s_lshl_b32 s3, s68, 11
    s_add_u32 s6, s6, s3
    v_lshrrev_b32 v1, 3, v23
    v_lshlrev_b32 v1, 11, v1
    v_and_b32 v3, 7, v23
    v_lshl_add_u32 v1, v3, 4, v1
    v_lshlrev_b32 v5, 2, v14
    v_lshl_add_u32 v5, v3, 4, v5
    v_lshlrev_b32 v3, 3, v3
    v_lshl_add_u32 v3, v14, 1, v3
    s_waitcnt lgkmcnt(10)
    v_max3_f32 v78, v30, v31, v32
    v_max3_f32 v78, v78, v33, v34
    v_max3_f32 v78, v78, v35, v36
    v_max_f32 v78, v78, v37
    v_sub_f32 v30, v30, v78
    v_sub_f32 v31, v31, v78
    v_sub_f32 v32, v32, v78
    v_sub_f32 v33, v33, v78
    v_sub_f32 v34, v34, v78
    v_sub_f32 v35, v35, v78
    v_sub_f32 v36, v36, v78
    v_sub_f32 v37, v37, v78
    v_exp_f32 v30, v30
    v_exp_f32 v31, v31
    v_exp_f32 v32, v32
    v_exp_f32 v33, v33
    v_exp_f32 v34, v34
    v_exp_f32 v35, v35
    v_exp_f32 v36, v36
    v_exp_f32 v37, v37
    s_waitcnt lgkmcnt(8)
    v_mul_f32 v79, v30, v38
    v_fmac_f32 v79, v31, v39
    v_fmac_f32 v79, v32, v40
    v_fmac_f32 v79, v33, v41
    v_fmac_f32 v79, v34, v42
    v_fmac_f32 v79, v35, v43
    v_fmac_f32 v79, v36, v44
    v_fmac_f32 v79, v37, v45
    v_rcp_f32 v38, v79
    v_log_f32 v39, v79
    s_waitcnt lgkmcnt(0)
    v_mul_f32 v46, v46, v30
    v_mul_f32 v47, v47, v30
    v_mul_f32 v48, v48, v30
    v_mul_f32 v49, v49, v30
    v_pk_fma_f32 v[46:47], v[50:51], v[30:31], v[46:47] op_sel:[0,1,0] op_sel_hi:[1,1,1]
    v_pk_fma_f32 v[48:49], v[52:53], v[30:31], v[48:49] op_sel:[0,1,0] op_sel_hi:[1,1,1]
    v_pk_fma_f32 v[46:47], v[54:55], v[32:33], v[46:47] op_sel:[0,0,0] op_sel_hi:[1,0,1]
    v_pk_fma_f32 v[48:49], v[56:57], v[32:33], v[48:49] op_sel:[0,0,0] op_sel_hi:[1,0,1]
    v_pk_fma_f32 v[46:47], v[58:59], v[32:33], v[46:47] op_sel:[0,1,0] op_sel_hi:[1,1,1]
    v_pk_fma_f32 v[48:49], v[60:61], v[32:33], v[48:49] op_sel:[0,1,0] op_sel_hi:[1,1,1]
    v_pk_fma_f32 v[46:47], v[62:63], v[34:35], v[46:47] op_sel:[0,0,0] op_sel_hi:[1,0,1]
    v_pk_fma_f32 v[48:49], v[64:65], v[34:35], v[48:49] op_sel:[0,0,0] op_sel_hi:[1,0,1]
    v_pk_fma_f32 v[46:47], v[66:67], v[34:35], v[46:47] op_sel:[0,1,0] op_sel_hi:[1,1,1]
    v_pk_fma_f32 v[48:49], v[68:69], v[34:35], v[48:49] op_sel:[0,1,0] op_sel_hi:[1,1,1]
    v_pk_fma_f32 v[46:47], v[70:71], v[36:37], v[46:47] op_sel:[0,0,0] op_sel_hi:[1,0,1]
    v_pk_fma_f32 v[48:49], v[72:73], v[36:37], v[48:49] op_sel:[0,0,0] op_sel_hi:[1,0,1]
    v_pk_fma_f32 v[46:47], v[74:75], v[36:37], v[46:47] op_sel:[0,1,0] op_sel_hi:[1,1,1]
    v_pk_fma_f32 v[48:49], v[76:77], v[36:37], v[48:49] op_sel:[0,1,0] op_sel_hi:[1,1,1]
    v_mul_f32 v46, v46, v38
    v_mul_f32 v47, v47, v38
    v_mul_f32 v48, v48, v38
    v_mul_f32 v49, v49, v38
    v_add_f32 v54, v78, v39
    v_mov_b32 v55, s90
    v_mov_b32 v56, s90
    v_mov_b32 v57, s90
    s_mov_b32 s32, 0x07060500
    v_perm_b32 v46, v46, v55, s32
    s_mov_b32 s32, 0x07060501
    v_perm_b32 v47, v47, v55, s32
    s_mov_b32 s32, 0x07060502
    v_perm_b32 v48, v48, v55, s32
    s_mov_b32 s32, 0x07060503
    v_perm_b32 v49, v49, v55, s32
    buffer_store_dwordx4 v[46:49], v2, s[56:59], s6 offen sc1
    s_mov_b32 exec_lo, 0xff
    s_mov_b32 exec_hi, 0xff
    buffer_store_dwordx4 v[54:57], v5, s[56:59], s6 offen offset:1024 sc1
    s_mov_b64 exec, -1
    s_mov_b32 s32, 0x0c0c0400
    s_mov_b32 s33, 0x04000c0c
    s_mov_b32 s89, 0
L_p2:
    buffer_load_dwordx4 v[58:61], v1, s[56:59], s7 offen sc1
    buffer_load_dwordx2 v[62:63], v1, s[56:59], s5 offen offset:1024 sc1
    s_add_u32 s89, s89, 1
    s_waitcnt vmcnt(0)
    v_perm_b32 v14, v59, v58, s32
    v_perm_b32 v15, v61, v60, s33
    v_or_b32 v14, v14, v15
    v_cmp_ne_u32 vcc, s90, v14
    v_cmp_ne_u32 s[92:93], s90, v63
    s_or_b64 exec, vcc, s[92:93]
    s_cmp_eq_u64 exec, 0
    s_cbranch_scc1 L_p2_x
    s_cmp_ge_u32 s89, 0x40000
    s_cbranch_scc1 L_p2_x
    s_sleep 1
    s_branch L_p2
L_p2_x:
    s_mov_b64 exec, -1
    v_and_b32 v66, 0xffffff00, v58
    v_and_b32 v67, 0xffffff00, v59
    v_and_b32 v68, 0xffffff00, v60
    v_and_b32 v69, 0xffffff00, v61
    v_mov_b32 v70, v62
    v_mov_b32 v78, v70
    s_nop 1
    v_max_f32_dpp v78, v78, v78 row_ror:8 row_mask:0xf bank_mask:0xf
    v_mov_b32 v5, v78
    s_nop 1
    v_permlane16_swap_b32 v78, v5
    s_nop 1
    v_max_f32 v78, v78, v5
    v_sub_f32 v78, v70, v78
    v_exp_f32 v78, v78
    s_nop 0
    v_mul_f32 v46, v66, v78
    v_mul_f32 v47, v67, v78
    v_mul_f32 v48, v68, v78
    v_mul_f32 v49, v69, v78
    s_nop 0
    v_add_f32_dpp v78, v78, v78 row_ror:8 row_mask:0xf bank_mask:0xf
    v_add_f32_dpp v46, v46, v46 row_ror:8 row_mask:0xf bank_mask:0xf
    v_add_f32_dpp v47, v47, v47 row_ror:8 row_mask:0xf bank_mask:0xf
    v_add_f32_dpp v48, v48, v48 row_ror:8 row_mask:0xf bank_mask:0xf
    v_add_f32_dpp v49, v49, v49 row_ror:8 row_mask:0xf bank_mask:0xf
    v_mov_b32 v66, v78
    v_mov_b32 v67, v46
    v_mov_b32 v68, v47
    v_mov_b32 v69, v48
    v_mov_b32 v70, v49
    s_nop 1
    v_permlane16_swap_b32 v78, v66
    v_permlane16_swap_b32 v46, v67
    v_permlane16_swap_b32 v47, v68
    v_permlane16_swap_b32 v48, v69
    v_permlane16_swap_b32 v49, v70
    s_nop 1
    v_add_f32 v78, v78, v66
    v_add_f32 v46, v46, v67
    v_add_f32 v47, v47, v68
    v_add_f32 v48, v48, v69
    v_add_f32 v49, v49, v70
    v_rcp_f32 v78, v78
    s_nop 0
    v_mul_f32 v46, v46, v78
    v_mul_f32 v47, v47, v78
    v_mul_f32 v48, v48, v78
    v_mul_f32 v49, v49, v78
    v_cvt_pk_bf16_f32 v46, v46, v47
    v_cvt_pk_bf16_f32 v47, v48, v49
    ds_write_b64 v3, v[46:47] offset:640
    s_branch L_w3
L_w2:
    s_cmp_lg_u32 s60, 1
    s_cbranch_scc1 L_w3
    s_lshr_b32 s3, s2, 3
    s_lshl_b32 s3, s3, 2
    s_and_b32 s4, s2, 3
    s_or_b32 s3, s3, s4
    s_cmp_ge_u32 s3, 72
    s_cbranch_scc1 L_w3
    s_mov_b32 s94, s3
    s_cmp_ge_u32 s3, 36
    s_cselect_b32 s4, 1, 0
    s_cselect_b32 s5, 36, 0
    s_sub_u32 s5, s3, s5
    s_lshr_b32 s6, s61, 4
    s_lshl_b32 s6, s6, 1
    s_add_u32 s4, s4, s6
    v_lshrrev_b32 v1, 2, v23
    v_and_b32 v3, 3, v23
    s_lshl_b32 s6, s4, 4
    v_add_u32 v1, s6, v1
    v_mul_u32_u24 v1, 18432, v1
    v_lshl_add_u32 v1, v3, 4, v1
    s_lshl_b32 s6, s5, 6
    v_add_u32 v1, s6, v1
    s_movk_i32 s10, 4608
    s_mov_b32 s11, 0x00020000
    s_movk_i32 s28, 9216
    s_movk_i32 s29, 13824
    s_and_b32 s7, s4, 1
    s_mul_i32 s7, s7, 2304
    s_lshr_b32 s6, s4, 1
    s_mul_i32 s6, s6, 1152
    s_add_u32 s7, s7, s6
    s_lshr_b32 s6, s5, 3
    s_lshl_b32 s6, s6, 8
    s_add_u32 s7, s7, s6
    s_cmp_ge_u32 s5, 32
    s_cselect_b32 s6, 1, 2
    s_cselect_b32 s3, 1, 3
    s_lshr_b32 s6, s5, s6
    s_and_b32 s6, s6, 1
    s_lshl_b32 s6, s6, 3
    s_add_u32 s7, s7, s6
    s_and_b32 s6, s5, s3
    s_lshl_b32 s6, s6, 6
    s_add_u32 s7, s7, s6
    v_lshlrev_b32 v3, 4, v3
    s_mov_b64 s[12:13], -1
    s_mov_b64 s[14:15], -1
    s_mov_b64 s[16:17], -1
    s_mov_b64 s[18:19], -1
    s_mov_b64 s[20:21], -1
    s_mov_b64 s[22:23], -1
    s_mov_b64 s[24:25], -1
    s_mov_b64 s[26:27], -1
    s_mov_b32 s32, 0x0c0c0400
    s_mov_b32 s33, 0x04000c0c
    s_waitcnt lgkmcnt(0)
    s_barrier
    s_mov_b32 s89, 0
L_p3:
    s_mov_b64 exec, s[12:13]
    buffer_load_dwordx4 v[46:49], v1, s[56:59], 0 offen offset:0 sc1
    s_mov_b64 exec, s[14:15]
    buffer_load_dwordx4 v[50:53], v1, s[56:59], 0 offen offset:2304 sc1
    s_mov_b64 exec, s[16:17]
    buffer_load_dwordx4 v[54:57], v1, s[56:59], s10 offen offset:0 sc1
    s_mov_b64 exec, s[18:19]
    buffer_load_dwordx4 v[58:61], v1, s[56:59], s10 offen offset:2304 sc1
    s_mov_b64 exec, s[20:21]
    buffer_load_dwordx4 v[62:65], v1, s[56:59], s28 offen offset:0 sc1
    s_mov_b64 exec, s[22:23]
    buffer_load_dwordx4 v[66:69], v1, s[56:59], s28 offen offset:2304 sc1
    s_mov_b64 exec, s[24:25]
    buffer_load_dwordx4 v[70:73], v1, s[56:59], s29 offen offset:0 sc1
    s_mov_b64 exec, s[26:27]
    buffer_load_dwordx4 v[74:77], v1, s[56:59], s29 offen offset:2304 sc1
    s_add_u32 s89, s89, 1
    s_mov_b64 exec, s[12:13]
    s_waitcnt vmcnt(7)
    v_perm_b32 v14, v47, v46, s32
    v_perm_b32 v15, v49, v48, s33
    v_or_b32 v14, v14, v15
    v_cmp_ne_u32 s[12:13], s90, v14
    s_mov_b64 exec, s[14:15]
    s_waitcnt vmcnt(6)
    v_perm_b32 v14, v51, v50, s32
    v_perm_b32 v15, v53, v52, s33
    v_or_b32 v14, v14, v15
    v_cmp_ne_u32 s[14:15], s90, v14
    s_mov_b64 exec, s[16:17]
    s_waitcnt vmcnt(5)
    v_perm_b32 v14, v55, v54, s32
    v_perm_b32 v15, v57, v56, s33
    v_or_b32 v14, v14, v15
    v_cmp_ne_u32 s[16:17], s90, v14
    s_mov_b64 exec, s[18:19]
    s_waitcnt vmcnt(4)
    v_perm_b32 v14, v59, v58, s32
    v_perm_b32 v15, v61, v60, s33
    v_or_b32 v14, v14, v15
    v_cmp_ne_u32 s[18:19], s90, v14
    s_mov_b64 exec, s[20:21]
    s_waitcnt vmcnt(3)
    v_perm_b32 v14, v63, v62, s32
    v_perm_b32 v15, v65, v64, s33
    v_or_b32 v14, v14, v15
    v_cmp_ne_u32 s[20:21], s90, v14
    s_mov_b64 exec, s[22:23]
    s_waitcnt vmcnt(2)
    v_perm_b32 v14, v67, v66, s32
    v_perm_b32 v15, v69, v68, s33
    v_or_b32 v14, v14, v15
    v_cmp_ne_u32 s[22:23], s90, v14
    s_mov_b64 exec, s[24:25]
    s_waitcnt vmcnt(1)
    v_perm_b32 v14, v71, v70, s32
    v_perm_b32 v15, v73, v72, s33
    v_or_b32 v14, v14, v15
    v_cmp_ne_u32 s[24:25], s90, v14
    s_mov_b64 exec, s[26:27]
    s_waitcnt vmcnt(0)
    v_perm_b32 v14, v75, v74, s32
    v_perm_b32 v15, v77, v76, s33
    v_or_b32 v14, v14, v15
    v_cmp_ne_u32 s[26:27], s90, v14
    s_mov_b64 exec, -1
    s_or_b64 s[92:93], s[12:13], s[14:15]
    s_or_b64 s[92:93], s[92:93], s[16:17]
    s_or_b64 s[92:93], s[92:93], s[18:19]
    s_or_b64 s[92:93], s[92:93], s[20:21]
    s_or_b64 s[92:93], s[92:93], s[22:23]
    s_or_b64 s[92:93], s[92:93], s[24:25]
    s_or_b64 s[92:93], s[92:93], s[26:27]
    s_bcnt1_i32_b64 s6, s[92:93]
    s_cmp_eq_u32 s6, 0
    s_cbranch_scc1 L_p3_x
    s_cmp_ge_u32 s89, 0x40000
    s_cbranch_scc1 L_p3_x
    s_branch L_p3
L_p3_x:
    v_and_b32 v80, 0xffffff00, v46
    v_and_b32 v81, 0xffffff00, v47
    v_and_b32 v82, 0xffffff00, v48
    v_and_b32 v83, 0xffffff00, v49
    v_and_b32 v84, 0xffffff00, v50
    v_and_b32 v85, 0xffffff00, v51
    v_and_b32 v86, 0xffffff00, v52
    v_and_b32 v87, 0xffffff00, v53
    v_and_b32 v88, 0xffffff00, v54
    v_and_b32 v89, 0xffffff00, v55
    v_and_b32 v90, 0xffffff00, v56
    v_and_b32 v91, 0xffffff00, v57
    v_and_b32 v92, 0xffffff00, v58
    v_and_b32 v93, 0xffffff00, v59
    v_and_b32 v94, 0xffffff00, v60
    v_and_b32 v95, 0xffffff00, v61
    v_and_b32 v96, 0xffffff00, v62
    v_and_b32 v97, 0xffffff00, v63
    v_and_b32 v98, 0xffffff00, v64
    v_and_b32 v99, 0xffffff00, v65
    v_and_b32 v100, 0xffffff00, v66
    v_and_b32 v101, 0xffffff00, v67
    v_and_b32 v102, 0xffffff00, v68
    v_and_b32 v103, 0xffffff00, v69
    v_and_b32 v104, 0xffffff00, v70
    v_and_b32 v105, 0xffffff00, v71
    v_and_b32 v106, 0xffffff00, v72
    v_and_b32 v107, 0xffffff00, v73
    v_and_b32 v108, 0xffffff00, v74
    v_and_b32 v109, 0xffffff00, v75
    v_and_b32 v110, 0xffffff00, v76
    v_and_b32 v111, 0xffffff00, v77
    v_pk_add_f32 v[80:81], v[80:81], v[96:97]
    v_pk_add_f32 v[82:83], v[82:83], v[98:99]
    v_pk_add_f32 v[84:85], v[84:85], v[100:101]
    v_pk_add_f32 v[86:87], v[86:87], v[102:103]
    v_pk_add_f32 v[88:89], v[88:89], v[104:105]
    v_pk_add_f32 v[90:91], v[90:91], v[106:107]
    v_pk_add_f32 v[92:93], v[92:93], v[108:109]
    v_pk_add_f32 v[94:95], v[94:95], v[110:111]
    v_pk_add_f32 v[80:81], v[80:81], v[88:89]
    v_pk_add_f32 v[82:83], v[82:83], v[90:91]
    v_pk_add_f32 v[84:85], v[84:85], v[92:93]
    v_pk_add_f32 v[86:87], v[86:87], v[94:95]
    v_pk_add_f32 v[80:81], v[80:81], v[84:85]
    v_pk_add_f32 v[82:83], v[82:83], v[86:87]
    s_nop 1
    v_add_f32_dpp v80, v80, v80 row_ror:4 row_mask:0xf bank_mask:0xf
    v_add_f32_dpp v81, v81, v81 row_ror:4 row_mask:0xf bank_mask:0xf
    v_add_f32_dpp v82, v82, v82 row_ror:4 row_mask:0xf bank_mask:0xf
    v_add_f32_dpp v83, v83, v83 row_ror:4 row_mask:0xf bank_mask:0xf
    s_nop 1
    v_add_f32_dpp v80, v80, v80 row_ror:8 row_mask:0xf bank_mask:0xf
    v_add_f32_dpp v81, v81, v81 row_ror:8 row_mask:0xf bank_mask:0xf
    v_add_f32_dpp v82, v82, v82 row_ror:8 row_mask:0xf bank_mask:0xf
    v_add_f32_dpp v83, v83, v83 row_ror:8 row_mask:0xf bank_mask:0xf
    v_mov_b32 v84, v80
    v_mov_b32 v85, v81
    v_mov_b32 v86, v82
    v_mov_b32 v87, v83
    s_nop 1
    v_permlane16_swap_b32 v80, v84
    v_permlane16_swap_b32 v81, v85
    v_permlane16_swap_b32 v82, v86
    v_permlane16_swap_b32 v83, v87
    s_nop 1
    v_add_f32 v80, v80, v84
    v_add_f32 v81, v81, v85
    v_add_f32 v82, v82, v86
    v_add_f32 v83, v83, v87
    v_mov_b32 v84, v80
    v_mov_b32 v85, v81
    v_mov_b32 v86, v82
    v_mov_b32 v87, v83
    s_nop 1
    v_permlane32_swap_b32 v80, v84
    v_permlane32_swap_b32 v81, v85
    v_permlane32_swap_b32 v82, v86
    v_permlane32_swap_b32 v83, v87
    s_nop 1
    v_add_f32 v80, v80, v84
    v_add_f32 v81, v81, v85
    v_add_f32 v82, v82, v86
    v_add_f32 v83, v83, v87
    v_cvt_pk_bf16_f32 v80, v80, v81
    v_cvt_pk_bf16_f32 v81, v82, v83
    s_mov_b64 exec, 15
    buffer_store_dwordx2 v[80:81], v3, s[84:87], s7 offen sc1
    s_cmp_lg_u32 s94, 0
    s_cbranch_scc1 L_nb
    s_mov_b64 exec, 1
    v_mov_b32 v14, s90
    buffer_store_dword v14, v3, s[56:59], s91 offen sc1
L_nb:
    s_endpgm
L_w3:
    v_mov_b32 v78, s90
    s_mov_b32 s12, 0x07060500
    s_mov_b32 s13, 0x07060501
    s_mov_b32 s14, 0x07060502
    s_mov_b32 s15, 0x07060503
    s_waitcnt lgkmcnt(0)
    s_barrier
L_fw:
    s_sub_u32 s3, s60, 3
    s_cmp_gt_u32 s3, 4
    s_cbranch_scc1 L_end
    ds_read_b128 v[46:49], v18 offset:640
    s_waitcnt vmcnt(0) lgkmcnt(0)
    v_perm_b32 v5, v46, v46, s34
    v_and_b32 v14, v5, v6
    v_and_b32 v15, v5, v7
    v_and_b32 v16, v5, v8
    v_and_b32 v17, v5, v9
    s_nop 1
    v_mfma_f32_16x16x32_bf16 v[10:13], v[14:17], v[160:163], 0
    v_perm_b32 v5, v46, v46, s35
    v_and_b32 v18, v5, v6
    v_and_b32 v19, v5, v7
    v_and_b32 v20, v5, v8
    v_and_b32 v21, v5, v9
    s_nop 1
    v_mfma_f32_16x16x32_bf16 v[10:13], v[18:21], v[164:167], v[10:13]
    v_perm_b32 v5, v47, v47, s34
    v_and_b32 v14, v5, v6
    v_and_b32 v15, v5, v7
    v_and_b32 v16, v5, v8
    v_and_b32 v17, v5, v9
    s_nop 1
    v_mfma_f32_16x16x32_bf16 v[10:13], v[14:17], v[168:171], v[10:13]
    v_perm_b32 v5, v47, v47, s35
    v_and_b32 v18, v5, v6
    v_and_b32 v19, v5, v7
    v_and_b32 v20, v5, v8
    v_and_b32 v21, v5, v9
    s_nop 1
    v_mfma_f32_16x16x32_bf16 v[10:13], v[18:21], v[172:175], v[10:13]
    v_perm_b32 v5, v48, v48, s34
    v_and_b32 v14, v5, v6
    v_and_b32 v15, v5, v7
    v_and_b32 v16, v5, v8
    v_and_b32 v17, v5, v9
    s_nop 1
    v_mfma_f32_16x16x32_bf16 v[10:13], v[14:17], v[176:179], v[10:13]
    v_perm_b32 v5, v48, v48, s35
    v_and_b32 v18, v5, v6
    v_and_b32 v19, v5, v7
    v_and_b32 v20, v5, v8
    v_and_b32 v21, v5, v9
    s_nop 1
    v_mfma_f32_16x16x32_bf16 v[10:13], v[18:21], v[180:183], v[10:13]
    v_perm_b32 v5, v49, v49, s34
    v_and_b32 v14, v5, v6
    v_and_b32 v15, v5, v7
    v_and_b32 v16, v5, v8
    v_and_b32 v17, v5, v9
    s_nop 1
    v_mfma_f32_16x16x32_bf16 v[10:13], v[14:17], v[184:187], v[10:13]
    v_perm_b32 v5, v49, v49, s35
    v_and_b32 v18, v5, v6
    v_and_b32 v19, v5, v7
    v_and_b32 v20, v5, v8
    v_and_b32 v21, v5, v9
    s_nop 1
    v_mfma_f32_16x16x32_bf16 v[10:13], v[18:21], v[188:191], v[10:13]
    s_nop 7
    s_nop 2
    v_perm_b32 v10, v10, v78, s12
    v_perm_b32 v11, v11, v78, s13
    v_perm_b32 v12, v12, v78, s14
    v_perm_b32 v13, v13, v78, s15
    buffer_store_dwordx4 v[10:13], v27, s[56:59], s88 offen sc1
L_ts:
L_end:
    s_endpgm
.section .rodata,"a"
.p2align 6
.amdhsa_kernel concat_heads__sliding_block_cached__sliding_block_cached__decode_kernel
  .amdhsa_next_free_vgpr 256
  .amdhsa_next_free_sgpr 96
  .amdhsa_accum_offset 256
  .amdhsa_group_segment_fixed_size 0
  .amdhsa_kernarg_size 104
  .amdhsa_user_sgpr_count 2
  .amdhsa_user_sgpr_kernarg_segment_ptr 1
  .amdhsa_system_sgpr_workgroup_id_x 1
.end_amdhsa_kernel
```
